```python
import torch

def _softmax(x, axis=-1):
    return torch.softmax(x, dim=axis)
def _gelu(x):
    return torch.nn.functional.gelu(x, approximate="tanh")
def _silu(x):
    return torch.nn.functional.silu(x)
def _sigmoid(x):
    return torch.sigmoid(x)
def _layernorm(x, axis=-1, eps=1e-5):
    m = x.mean(dim=axis, keepdim=True)
    v = x.var(dim=axis, keepdim=True, unbiased=False)
    return (x - m) / torch.sqrt(v + eps)
def _scatter_add(tgt, idx, src, axis=0):
    return tgt.clone().index_add_(axis, idx, src)
def _segment_sum(src, seg, n):
    out = torch.zeros((n,) + src.shape[1:], dtype=src.dtype)
    return out.index_add_(0, seg, src)
def _pad(x, pw):
    flat = tuple(v for pair in reversed(pw) for v in pair)
    return torch.nn.functional.pad(x, flat)

kernel_name = 'sequential_preLN__spectral_fnet__glu_gated_glu__prompt'

def setup_inputs():

    _w = (lambda a: (lambda t: t.to(torch.bfloat16) if t.is_floating_point() else t)(torch.as_tensor(a)))
    def _A_setup():
        B, S, D = 1, 2048, 640
        ns = torch.arange(S)[:, None] * torch.arange(S)[None, :]
        nd = torch.arange(D)[:, None] * torch.arange(D)[None, :]
        Ws_re = torch.cos(-2.0 * torch.pi * ns / S).to(float)
        Ws_im = torch.sin(-2.0 * torch.pi * ns / S).to(float)
        Wd_re = torch.cos(-2.0 * torch.pi * nd / D).to(float)
        Wd_im = torch.sin(-2.0 * torch.pi * nd / D).to(float)
        return {
            "x": _w((lambda *s: torch.randn(*s, dtype=torch.bfloat16) * 0.05)(B, S, D)),
            "dft_seq_re": _w(Ws_re),
            "dft_seq_im": _w(Ws_im),
            "dft_hid_re": _w(Wd_re),
            "dft_hid_im": _w(Wd_im),
        }
    _A_in = _A_setup()

    def _B_setup():
        B, S, D, F = 1, 2048, 640, 1536
        return {
            "x": _w((lambda *s: torch.randn(*s, dtype=torch.bfloat16) * 0.05)(B, S, D)),
            "w_gate": _w((lambda *s: torch.randn(*s, dtype=torch.bfloat16) * 1.6)(D, F)),
            "w_up": _w((lambda *s: torch.randn(*s, dtype=torch.bfloat16) * 0.8)(D, F)),
            "w_down": _w((lambda *s: torch.randn(*s, dtype=torch.bfloat16) * 0.8)(F, D)),
        }
    _B_in = _B_setup()

    return {
        "A_x": _A_in["x"],
        "A_dft_seq_re": _A_in["dft_seq_re"],
        "A_dft_seq_im": _A_in["dft_seq_im"],
        "A_dft_hid_re": _A_in["dft_hid_re"],
        "A_dft_hid_im": _A_in["dft_hid_im"],
        "B_x": _B_in["x"],
        "B_w_gate": _B_in["w_gate"],
        "B_w_up": _B_in["w_up"],
        "B_w_down": _B_in["w_down"],
    }

def reference(A_x, A_dft_seq_re, A_dft_seq_im, A_dft_hid_re, A_dft_hid_im, B_x, B_w_gate, B_w_up, B_w_down):
    def _A_ref(x, dft_seq_re, dft_seq_im, dft_hid_re, dft_hid_im):
        a = torch.einsum("bsd,ed->bse", x, dft_hid_re)
        b = torch.einsum("bsd,ed->bse", x, dft_hid_im)
        y = torch.einsum("ts,bse->bte", dft_seq_re, a) - torch.einsum("ts,bse->bte", dft_seq_im, b)
        return y

    def _B_ref(x, w_gate, w_up, w_down):
        g = torch.einsum("bsd,df->bsf", x, w_gate)
        u = torch.einsum("bsd,df->bsf", x, w_up)
        h = _sigmoid(g) * u
        return torch.einsum("bsf,fd->bsd", h, w_down)

    x = A_x
    h = x + _A_ref(_layernorm(x, axis=-1), A_dft_seq_re, A_dft_seq_im, A_dft_hid_re, A_dft_hid_im)
    h2 = h + _B_ref(_layernorm(h, axis=-1), B_w_gate, B_w_up, B_w_down)
    return h2
```

```asm
; @launch grid=(256,1,1) block=(256,1,1) lds=163840
.amdgcn_target "amdgcn-amd-amdhsa--gfx950"
.text
.globl sequential_preLN__spectral_fnet__glu_gated_glu__prompt_kernel
.p2align 12
.p2align 8
.type sequential_preLN__spectral_fnet__glu_gated_glu__prompt_kernel,@function
sequential_preLN__spectral_fnet__glu_gated_glu__prompt_kernel:
    s_load_dwordx2 s[4:5], s[0:1], 0
    s_cmp_ge_u32 s2, 256
    s_cbranch_scc1 L_end
    s_load_dwordx2 s[24:25], s[0:1], 88
    s_load_dwordx2 s[16:17], s[0:1], 64
    s_load_dwordx2 s[8:9], s[0:1], 48
    s_load_dwordx2 s[12:13], s[0:1], 56
    s_load_dwordx2 s[20:21], s[0:1], 72
    s_getpc_b64 s[34:35]
L_pc:
    v_lshlrev_b32 v2, 7, v0
    v_min_u32 v2, L_end-L_pc, v2
    v_add_co_u32 v2, vcc, s34, v2
    v_mov_b32 v3, s35
    v_lshrrev_b32 v5, 6, v0
    v_addc_co_u32 v3, vcc, 0, v3, vcc
    global_load_dword v1, v[2:3], off
    v_readfirstlane_b32 s33, v5
    v_lshrrev_b32 v5, 3, v0
    v_and_b32 v6, 7, v0
    v_mul_u32_u24 v100, 81920, v5
    s_and_b32 s28, s2, 7
    s_lshr_b32 s29, s2, 5
    s_lshr_b32 s30, s2, 7
    s_lshl1_add_u32 s45, s28, s30
    s_cmp_eq_u32 s45, 0
    s_cselect_b32 s46, 16, s45
    s_sub_u32 s30, 64, s46
    s_bitcmp1_b32 s2, 6
    s_cselect_b32 s34, s30, s45
    s_and_b32 s30, s2, 32
    s_xor_b32 s34, s34, s30
    v_lshl_add_u32 v100, v6, 4, v100
    s_mul_i32 s44, s34, 1280
    s_and_b32 s30, s2, 8
    s_mul_i32 s30, s30, 80
    s_add_u32 s43, s44, s30
    s_mov_b32 s6, 2621440
    s_mov_b32 s7, 0x20000
    s_mov_b32 s10, 1966080
    s_mov_b32 s11, 0x20000
    s_mov_b32 s14, 1966080
    s_mov_b32 s15, 0x20000
    s_mov_b32 s18, 1966080
    s_mov_b32 s19, 0x20000
    s_mov_b32 s22, 2621440
    s_mov_b32 s23, 0x20000
    s_mov_b32 s26, 14286848
    s_mov_b32 s27, 0x20000
    v_and_b32 v4, 63, v0
    s_bfe_u32 s35, s2, 0x20003
    s_and_b32 s40, s33, 1
    s_lshr_b32 s41, s33, 1
    s_sub_u32 s44, s44, s30
    s_add_u32 s44, s44, 640
    s_lshl3_add_u32 s48, s28, s29
    s_and_b32 s47, s29, 3
    s_and_b32 s42, s2, 3
    s_and_b32 s36, s2, 4
    s_lshl1_add_u32 s36, s36, s29
    s_lshl2_add_u32 s37, s42, s35
    s_lshr_b32 s49, s35, 1
    s_and_b32 s39, s35, 1
    s_lshl2_add_u32 s38, s49, s47
    s_lshl1_add_u32 s50, s39, s41
    s_mul_i32 s50, s50, 80
    s_add_u32 s50, s50, 2
    s_sub_u32 s50, s50, s49
    s_lshl3_add_u32 s51, s40, s50
    v_lshrrev_b32 v5, 4, v4
    v_lshlrev_b32 v5, 3, v5
    v_cvt_f32_u32 v92, v5
    v_bfe_u32 v5, v4, 3, 1
    v_cvt_f32_u32 v93, v5
    v_mul_f32 v93, 0x3e800000, v93
    v_mul_u32_u24 v11, 0x8000, v5
    v_lshl_or_b32 v11, v11, 16, v11
    v_and_b32 v12, s49, v5
    v_bfe_u32 v5, v4, 2, 1
    v_and_b32 v6, 3, v4
    v_lshlrev_b32 v5, 5, v5
    v_lshl_add_u32 v94, v6, 1, v5
    s_and_b32 s28, s48, 1
    s_lshl1_add_u32 s52, s35, s28
    s_lshr_b32 s53, s48, 1
    s_mul_i32 s28, s53, 61440
    s_mul_i32 s29, s52, 160
    s_add_u32 s54, s28, s29
    s_lshl_b32 s29, s33, 7
    s_lshl_b32 s55, s33, 11
    v_add3_u32 v5, s29, v4, 0
    v_mul_u32_u24 v6, 6554, v5
    v_lshrrev_b32 v6, 16, v6
    v_mul_u32_u24 v7, 1120, v6
    v_lshl_add_u32 v13, v5, 4, v7
    v_add3_u32 v5, s29, v4, 64
    v_mul_u32_u24 v6, 6554, v5
    v_lshrrev_b32 v6, 16, v6
    v_mul_u32_u24 v7, 1120, v6
    v_lshl_add_u32 v14, v5, 4, v7
    s_mul_i32 s28, s40, 60
    v_min_u32 v5, 59, v4
    v_add_u32 v5, s28, v5
    v_mul_u32_u24 v6, 10923, v5
    v_lshrrev_b32 v6, 16, v6
    v_mul_u32_u24 v15, 2304, v6
    v_lshl_add_u32 v15, v5, 7, v15
    s_lshr_b32 s56, s2, 3
    s_mul_i32 s56, s56, 61440
    s_mul_i32 s28, s42, 768
    s_add_u32 s56, s56, s28
    v_add_u32 v95, s51, v94
    v_lshrrev_b32 v90, 1, v95
    v_xor_b32 v12, v12, v90
    v_lshlrev_b32 v12, 31, v12
    v_or_b32 v12, 1.0, v12
    v_cvt_f32_u32 v95, v95
    v_mul_f32 v90, 0x3acccccd, v95
    v_mul_f32 v95, 0x3d4ccccd, v95
    v_fma_f32 v91, v90, v92, v93
    v_cos_f32 v88, v95
    v_cos_f32 v95, v90
    v_fmamk_f32 v80, v90, 0x42000000, v91
    v_add_f32 v73, v90, v91
    v_add_f32 v81, v90, v80
    v_cos_f32 v72, v91
    v_cos_f32 v73, v73
    v_cos_f32 v80, v80
    v_cos_f32 v81, v81
    s_waitcnt lgkmcnt(0)
    buffer_load_dwordx4 v[32:35], v100, s[4:7], s43 offen offset:0
    buffer_load_dwordx4 v[36:39], v100, s[4:7], s43 offen offset:128
    buffer_load_dwordx4 v[40:43], v100, s[4:7], s43 offen offset:256
    buffer_load_dwordx4 v[44:47], v100, s[4:7], s43 offen offset:384
    s_cmp_eq_u32 s41, 0
    s_cselect_b32 s8, s8, s12
    s_cselect_b32 s9, s9, s13
    s_min_u32 s89, s33, 2
    s_lshl_b32 s89, s89, 8
    s_add_u32 s89, s89, s2
    s_lshl_b32 s89, s89, 7
    s_load_dword s88, s[24:25], s89 glc
    v_add_f32 v95, v95, v95
    buffer_load_dwordx4 v[48:51], v100, s[4:7], s43 offen offset:512
    v_add_f32 v88, v88, v88
    v_fma_f32 v74, v95, v73, -v72
    v_fma_f32 v82, v95, v81, -v80
    v_fma_f32 v75, v95, v74, -v73
    v_fma_f32 v83, v95, v82, -v81
    v_fma_f32 v76, v95, v75, -v74
    v_fma_f32 v84, v95, v83, -v82
    v_fma_f32 v77, v95, v76, -v75
    v_fma_f32 v85, v95, v84, -v83
    v_fma_f32 v78, v95, v77, -v76
    buffer_load_dwordx4 v[52:55], v100, s[4:7], s44 offen offset:0
    v_fma_f32 v86, v95, v85, -v84
    v_fma_f32 v79, v95, v78, -v77
    v_fma_f32 v87, v95, v86, -v85
    v_cvt_pk_bf16_f32 v192, v72, v73
    v_cvt_pk_bf16_f32 v193, v74, v75
    v_cvt_pk_bf16_f32 v194, v76, v77
    v_cvt_pk_bf16_f32 v195, v78, v79
    v_cvt_pk_bf16_f32 v196, v80, v81
    v_cvt_pk_bf16_f32 v197, v82, v83
    v_cvt_pk_bf16_f32 v198, v84, v85
    buffer_load_dwordx4 v[56:59], v100, s[4:7], s44 offen offset:128
    v_cvt_pk_bf16_f32 v199, v86, v87
    v_pk_fma_f32 v[72:73], v[80:81], v[88:89], v[72:73] op_sel_hi:[1,0,1] neg_lo:[0,0,1] neg_hi:[0,0,1]
    v_pk_fma_f32 v[74:75], v[82:83], v[88:89], v[74:75] op_sel_hi:[1,0,1] neg_lo:[0,0,1] neg_hi:[0,0,1]
    v_pk_fma_f32 v[76:77], v[84:85], v[88:89], v[76:77] op_sel_hi:[1,0,1] neg_lo:[0,0,1] neg_hi:[0,0,1]
    v_pk_fma_f32 v[78:79], v[86:87], v[88:89], v[78:79] op_sel_hi:[1,0,1] neg_lo:[0,0,1] neg_hi:[0,0,1]
    v_cvt_pk_bf16_f32 v200, v72, v73
    v_cvt_pk_bf16_f32 v201, v74, v75
    v_cvt_pk_bf16_f32 v202, v76, v77
    v_cvt_pk_bf16_f32 v203, v78, v79
    v_pk_fma_f32 v[80:81], v[72:73], v[88:89], v[80:81] op_sel_hi:[1,0,1] neg_lo:[0,0,1] neg_hi:[0,0,1]
    buffer_load_dwordx4 v[60:63], v100, s[4:7], s44 offen offset:256
    v_pk_fma_f32 v[82:83], v[74:75], v[88:89], v[82:83] op_sel_hi:[1,0,1] neg_lo:[0,0,1] neg_hi:[0,0,1]
    v_pk_fma_f32 v[84:85], v[76:77], v[88:89], v[84:85] op_sel_hi:[1,0,1] neg_lo:[0,0,1] neg_hi:[0,0,1]
    v_pk_fma_f32 v[86:87], v[78:79], v[88:89], v[86:87] op_sel_hi:[1,0,1] neg_lo:[0,0,1] neg_hi:[0,0,1]
    v_cvt_pk_bf16_f32 v204, v80, v81
    v_cvt_pk_bf16_f32 v205, v82, v83
    v_cvt_pk_bf16_f32 v206, v84, v85
    v_cvt_pk_bf16_f32 v207, v86, v87
    v_pk_fma_f32 v[72:73], v[80:81], v[88:89], v[72:73] op_sel_hi:[1,0,1] neg_lo:[0,0,1] neg_hi:[0,0,1]
    v_pk_fma_f32 v[74:75], v[82:83], v[88:89], v[74:75] op_sel_hi:[1,0,1] neg_lo:[0,0,1] neg_hi:[0,0,1]
    v_pk_fma_f32 v[76:77], v[84:85], v[88:89], v[76:77] op_sel_hi:[1,0,1] neg_lo:[0,0,1] neg_hi:[0,0,1]
    buffer_load_dwordx4 v[64:67], v100, s[4:7], s44 offen offset:384
    v_pk_fma_f32 v[78:79], v[86:87], v[88:89], v[78:79] op_sel_hi:[1,0,1] neg_lo:[0,0,1] neg_hi:[0,0,1]
    v_cvt_pk_bf16_f32 v208, v72, v73
    v_cvt_pk_bf16_f32 v209, v74, v75
    v_cvt_pk_bf16_f32 v210, v76, v77
    v_cvt_pk_bf16_f32 v211, v78, v79
    v_add3_u32 v95, s51, v94, 16
    v_cvt_f32_u32 v95, v95
    v_mul_f32 v90, 0x3acccccd, v95
    v_mul_f32 v95, 0x3d4ccccd, v95
    v_fma_f32 v91, v90, v92, v93
    buffer_load_dwordx4 v[68:71], v100, s[4:7], s44 offen offset:512
    v_cos_f32 v88, v95
    v_cos_f32 v95, v90
    v_fmamk_f32 v80, v90, 0x42000000, v91
    v_add_f32 v73, v90, v91
    v_add_f32 v81, v90, v80
    v_cos_f32 v72, v91
    v_cos_f32 v73, v73
    v_cos_f32 v80, v80
    v_cos_f32 v81, v81
    v_add_f32 v95, v95, v95
    v_add_f32 v88, v88, v88
    v_fma_f32 v74, v95, v73, -v72
    s_add_u32 m0, s55, 20480
    s_nop 0
    buffer_load_dwordx4 v13, s[16:19], s54 offen  lds
    v_fma_f32 v82, v95, v81, -v80
    v_fma_f32 v75, v95, v74, -v73
    v_fma_f32 v83, v95, v82, -v81
    v_fma_f32 v76, v95, v75, -v74
    v_fma_f32 v84, v95, v83, -v82
    v_fma_f32 v77, v95, v76, -v75
    v_fma_f32 v85, v95, v84, -v83
    v_fma_f32 v78, v95, v77, -v76
    v_fma_f32 v86, v95, v85, -v84
    v_fma_f32 v79, v95, v78, -v77
    v_fma_f32 v87, v95, v86, -v85
    v_cvt_pk_bf16_f32 v212, v72, v73
    v_cvt_pk_bf16_f32 v213, v74, v75
    v_cvt_pk_bf16_f32 v214, v76, v77
    v_cvt_pk_bf16_f32 v215, v78, v79
    v_cvt_pk_bf16_f32 v216, v80, v81
    v_cvt_pk_bf16_f32 v217, v82, v83
    v_cvt_pk_bf16_f32 v218, v84, v85
    v_cvt_pk_bf16_f32 v219, v86, v87
    v_pk_fma_f32 v[72:73], v[80:81], v[88:89], v[72:73] op_sel_hi:[1,0,1] neg_lo:[0,0,1] neg_hi:[0,0,1]
    v_pk_fma_f32 v[74:75], v[82:83], v[88:89], v[74:75] op_sel_hi:[1,0,1] neg_lo:[0,0,1] neg_hi:[0,0,1]
    v_pk_fma_f32 v[76:77], v[84:85], v[88:89], v[76:77] op_sel_hi:[1,0,1] neg_lo:[0,0,1] neg_hi:[0,0,1]
    v_pk_fma_f32 v[78:79], v[86:87], v[88:89], v[78:79] op_sel_hi:[1,0,1] neg_lo:[0,0,1] neg_hi:[0,0,1]
    v_cvt_pk_bf16_f32 v220, v72, v73
    v_cvt_pk_bf16_f32 v221, v74, v75
    v_cvt_pk_bf16_f32 v222, v76, v77
    v_cvt_pk_bf16_f32 v223, v78, v79
    v_pk_fma_f32 v[80:81], v[72:73], v[88:89], v[80:81] op_sel_hi:[1,0,1] neg_lo:[0,0,1] neg_hi:[0,0,1]
    v_pk_fma_f32 v[82:83], v[74:75], v[88:89], v[82:83] op_sel_hi:[1,0,1] neg_lo:[0,0,1] neg_hi:[0,0,1]
    v_pk_fma_f32 v[84:85], v[76:77], v[88:89], v[84:85] op_sel_hi:[1,0,1] neg_lo:[0,0,1] neg_hi:[0,0,1]
    v_pk_fma_f32 v[86:87], v[78:79], v[88:89], v[86:87] op_sel_hi:[1,0,1] neg_lo:[0,0,1] neg_hi:[0,0,1]
    v_cvt_pk_bf16_f32 v224, v80, v81
    v_cvt_pk_bf16_f32 v225, v82, v83
    v_cvt_pk_bf16_f32 v226, v84, v85
    v_cvt_pk_bf16_f32 v227, v86, v87
    v_pk_fma_f32 v[72:73], v[80:81], v[88:89], v[72:73] op_sel_hi:[1,0,1] neg_lo:[0,0,1] neg_hi:[0,0,1]
    v_pk_fma_f32 v[74:75], v[82:83], v[88:89], v[74:75] op_sel_hi:[1,0,1] neg_lo:[0,0,1] neg_hi:[0,0,1]
    v_pk_fma_f32 v[76:77], v[84:85], v[88:89], v[76:77] op_sel_hi:[1,0,1] neg_lo:[0,0,1] neg_hi:[0,0,1]
    v_pk_fma_f32 v[78:79], v[86:87], v[88:89], v[78:79] op_sel_hi:[1,0,1] neg_lo:[0,0,1] neg_hi:[0,0,1]
    v_cvt_pk_bf16_f32 v228, v72, v73
    v_cvt_pk_bf16_f32 v229, v74, v75
    v_cvt_pk_bf16_f32 v230, v76, v77
    v_cvt_pk_bf16_f32 v231, v78, v79
    v_and_b32 v95, 7, v4
    v_lshlrev_b32 v95, 1, v95
    v_add3_u32 v95, s50, v95, 64
    v_cvt_f32_u32 v95, v95
    v_mul_f32 v90, 0x3acccccd, v95
    v_mul_f32 v95, 0x3d4ccccd, v95
    v_fma_f32 v91, v90, v92, v93
    v_cos_f32 v88, v95
    v_cos_f32 v95, v90
    v_fmamk_f32 v80, v90, 0x42000000, v91
    v_add_f32 v73, v90, v91
    v_add_f32 v81, v90, v80
    v_cos_f32 v72, v91
    v_cos_f32 v73, v73
    v_cos_f32 v80, v80
    v_cos_f32 v81, v81
    v_add_f32 v95, v95, v95
    v_add_f32 v88, v88, v88
    v_fma_f32 v74, v95, v73, -v72
    v_fma_f32 v82, v95, v81, -v80
    v_fma_f32 v75, v95, v74, -v73
    v_fma_f32 v83, v95, v82, -v81
    v_fma_f32 v76, v95, v75, -v74
    v_fma_f32 v84, v95, v83, -v82
    v_fma_f32 v77, v95, v76, -v75
    s_add_u32 m0, s55, 21504
    s_nop 0
    buffer_load_dwordx4 v14, s[16:19], s54 offen  lds
    v_fma_f32 v85, v95, v84, -v83
    v_fma_f32 v78, v95, v77, -v76
    v_fma_f32 v86, v95, v85, -v84
    v_fma_f32 v79, v95, v78, -v77
    v_fma_f32 v87, v95, v86, -v85
    v_cvt_pk_bf16_f32 v232, v72, v73
    v_cvt_pk_bf16_f32 v233, v74, v75
    v_cvt_pk_bf16_f32 v234, v76, v77
    v_cvt_pk_bf16_f32 v235, v78, v79
    v_cvt_pk_bf16_f32 v236, v80, v81
    v_cvt_pk_bf16_f32 v237, v82, v83
    v_cvt_pk_bf16_f32 v238, v84, v85
    v_cvt_pk_bf16_f32 v239, v86, v87
    v_pk_fma_f32 v[72:73], v[80:81], v[88:89], v[72:73] op_sel_hi:[1,0,1] neg_lo:[0,0,1] neg_hi:[0,0,1]
    v_pk_fma_f32 v[74:75], v[82:83], v[88:89], v[74:75] op_sel_hi:[1,0,1] neg_lo:[0,0,1] neg_hi:[0,0,1]
    v_pk_fma_f32 v[76:77], v[84:85], v[88:89], v[76:77] op_sel_hi:[1,0,1] neg_lo:[0,0,1] neg_hi:[0,0,1]
    v_pk_fma_f32 v[78:79], v[86:87], v[88:89], v[78:79] op_sel_hi:[1,0,1] neg_lo:[0,0,1] neg_hi:[0,0,1]
    v_cvt_pk_bf16_f32 v240, v72, v73
    v_cvt_pk_bf16_f32 v241, v74, v75
    v_cvt_pk_bf16_f32 v242, v76, v77
    v_cvt_pk_bf16_f32 v243, v78, v79
    v_pk_fma_f32 v[80:81], v[72:73], v[88:89], v[80:81] op_sel_hi:[1,0,1] neg_lo:[0,0,1] neg_hi:[0,0,1]
    v_pk_fma_f32 v[82:83], v[74:75], v[88:89], v[82:83] op_sel_hi:[1,0,1] neg_lo:[0,0,1] neg_hi:[0,0,1]
    v_pk_fma_f32 v[84:85], v[76:77], v[88:89], v[84:85] op_sel_hi:[1,0,1] neg_lo:[0,0,1] neg_hi:[0,0,1]
    v_pk_fma_f32 v[86:87], v[78:79], v[88:89], v[86:87] op_sel_hi:[1,0,1] neg_lo:[0,0,1] neg_hi:[0,0,1]
    v_cvt_pk_bf16_f32 v244, v80, v81
    v_cvt_pk_bf16_f32 v245, v82, v83
    v_cvt_pk_bf16_f32 v246, v84, v85
    v_cvt_pk_bf16_f32 v247, v86, v87
    v_pk_fma_f32 v[72:73], v[80:81], v[88:89], v[72:73] op_sel_hi:[1,0,1] neg_lo:[0,0,1] neg_hi:[0,0,1]
    v_pk_fma_f32 v[74:75], v[82:83], v[88:89], v[74:75] op_sel_hi:[1,0,1] neg_lo:[0,0,1] neg_hi:[0,0,1]
    v_pk_fma_f32 v[76:77], v[84:85], v[88:89], v[76:77] op_sel_hi:[1,0,1] neg_lo:[0,0,1] neg_hi:[0,0,1]
    v_pk_fma_f32 v[78:79], v[86:87], v[88:89], v[78:79] op_sel_hi:[1,0,1] neg_lo:[0,0,1] neg_hi:[0,0,1]
    v_cvt_pk_bf16_f32 v248, v72, v73
    v_cvt_pk_bf16_f32 v249, v74, v75
    v_cvt_pk_bf16_f32 v250, v76, v77
    v_cvt_pk_bf16_f32 v251, v78, v79
    s_lshl_b32 s28, s40, 4
    v_and_b32 v5, 15, v4
    v_add_u32 v5, s28, v5
    buffer_load_dword v16, v15, s[8:11], s56 offen offset:0
    v_cvt_f32_u32 v5, v5
    v_mul_f32 v90, 0x3d000000, v5
    v_mul_f32 v91, v90, v92
    v_cos_f32 v88, v90
    v_add_f32 v95, v90, v91
    v_cos_f32 v72, v91
    v_sin_f32 v73, v91
    v_cos_f32 v74, v95
    v_sin_f32 v75, v95
    v_add_f32 v88, v88, v88
    s_mov_b32 s28, 0x80000000
    v_pk_fma_f32 v[76:77], v[74:75], v[88:89], v[72:73] op_sel_hi:[1,0,1] neg_lo:[0,0,1] neg_hi:[0,0,1]
    v_pk_fma_f32 v[78:79], v[76:77], v[88:89], v[74:75] op_sel_hi:[1,0,1] neg_lo:[0,0,1] neg_hi:[0,0,1]
    v_pk_fma_f32 v[80:81], v[78:79], v[88:89], v[76:77] op_sel_hi:[1,0,1] neg_lo:[0,0,1] neg_hi:[0,0,1]
    v_pk_fma_f32 v[82:83], v[80:81], v[88:89], v[78:79] op_sel_hi:[1,0,1] neg_lo:[0,0,1] neg_hi:[0,0,1]
    v_pk_fma_f32 v[84:85], v[82:83], v[88:89], v[80:81] op_sel_hi:[1,0,1] neg_lo:[0,0,1] neg_hi:[0,0,1]
    v_pk_fma_f32 v[86:87], v[84:85], v[88:89], v[82:83] op_sel_hi:[1,0,1] neg_lo:[0,0,1] neg_hi:[0,0,1]
    v_cvt_pk_f16_f32 v176, v72, v74
    v_cvt_pk_f16_f32 v180, v73, v75
    v_cvt_pk_f16_f32 v177, v76, v78
    v_cvt_pk_f16_f32 v181, v77, v79
    v_cvt_pk_f16_f32 v178, v80, v82
    v_cvt_pk_f16_f32 v182, v81, v83
    v_cvt_pk_f16_f32 v179, v84, v86
    v_cvt_pk_f16_f32 v183, v85, v87
    s_cmp_eq_u32 s40, 0
    s_cbranch_scc1 L_nosw
    v_swap_b32 v176, v178
    v_swap_b32 v177, v179
    v_swap_b32 v180, v182
    v_swap_b32 v181, v183
L_nosw:
    v_xor_b32 v184, s28, v176
    v_xor_b32 v185, s28, v177
    v_xor_b32 v186, s28, v178
    v_xor_b32 v187, s28, v179
    v_xor_b32 v188, s28, v180
    v_xor_b32 v189, s28, v181
    v_xor_b32 v190, s28, v182
    v_xor_b32 v191, s28, v183
    v_lshlrev_b32 v18, 4, v4
    v_and_b32 v5, 7, v4
    v_bfe_u32 v6, v4, 3, 2
    s_lshl_b32 s28, s33, 2
    v_add_u32 v6, s28, v6
    v_xor_b32 v6, v6, v5
    v_lshlrev_b32 v6, 4, v6
    v_lshl_add_u32 v6, v5, 8, v6
    v_lshrrev_b32 v7, 5, v4
    v_mul_u32_u24 v7, 10240, v7
    v_add_u32 v120, v6, v7
    v_lshrrev_b32 v5, 4, v4
    v_xor_b32 v6, v4, v5
    s_mul_i32 s28, s40, 10240
    v_lshl_add_u32 v121, v6, 4, s28
    v_xor_b32 v122, 64, v121
    s_mul_i32 s58, s37, 192
    s_mul_i32 s60, s41, 6144
    s_mul_i32 s28, s40, 3072
    s_add_u32 s60, s60, s28
    s_lshl_b32 s28, s40, 4
    s_add_u32 s29, s41, 2
    v_mul_u32_u24 v6, 5462, v4
    v_lshrrev_b32 v6, 16, v6
    v_mad_i32_i24 v7, v6, -12, v4
    v_xor_b32 v7, s41, v7
    v_add_u32 v22, s28, v6
    v_add_u32 v7, 128, v7
    v_mul_u32_u24 v19, 6144, v22
    v_lshl_add_u32 v19, v7, 4, v19
    v_add_u32 v8, 64, v4
    v_mul_u32_u24 v6, 5462, v8
    v_lshrrev_b32 v6, 16, v6
    v_mad_i32_i24 v7, v6, -12, v8
    v_lshrrev_b32 v8, 3, v6
    v_lshl_add_u32 v8, v8, 1, s41
    v_xor_b32 v7, v7, v8
    v_add_u32 v23, s28, v6
    v_add_u32 v7, 64, v7
    v_mul_u32_u24 v20, 6144, v23
    v_lshl_add_u32 v20, v7, 4, v20
    v_add_u32 v8, 128, v4
    v_mul_u32_u24 v6, 5462, v8
    v_lshrrev_b32 v6, 16, v6
    v_mad_i32_i24 v7, v6, -12, v8
    v_xor_b32 v7, s29, v7
    v_add_u32 v24, s28, v6
    v_mul_u32_u24 v21, 6144, v24
    v_lshl_add_u32 v21, v7, 4, v21
    s_mov_b32 s31, 98304
    buffer_load_dword v172, off, s[24:27], s31 sc1
    s_mov_b32 s12, 0x3f803f80
    s_mov_b32 s13, 0xffff0000
    s_cmp_eq_u32 s49, 0
    s_cselect_b32 s15, 1.0, -1.0
    s_cselect_b32 s43, -2.0, 0
    s_lshr_b32 s14, s15, 16
    v_mov_b32 v123, 0
    v_mov_b32 v126, 0
    v_mov_b32 v10, 0x3727c5ac
    s_and_b32 s32, s49, s39
    s_lshl_b32 s32, s32, 31
    s_waitcnt vmcnt(13)
    v_dot2c_f32_bf16 v123, s12, v32
    v_dot2c_f32_bf16 v126, v32, v32
    v_dot2c_f32_bf16 v123, s12, v33
    v_dot2c_f32_bf16 v126, v33, v33
    v_dot2c_f32_bf16 v123, s12, v34
    v_dot2c_f32_bf16 v126, v34, v34
    v_dot2c_f32_bf16 v123, s12, v35
    v_dot2c_f32_bf16 v126, v35, v35
    v_lshlrev_b32 v72, 16, v32
    v_and_b32 v73, s13, v32
    v_lshlrev_b32 v74, 16, v33
    v_and_b32 v75, s13, v33
    v_lshlrev_b32 v76, 16, v34
    v_and_b32 v77, s13, v34
    v_lshlrev_b32 v78, 16, v35
    v_and_b32 v79, s13, v35
    s_waitcnt vmcnt(12)
    v_dot2c_f32_bf16 v123, s12, v36
    v_dot2c_f32_bf16 v126, v36, v36
    v_dot2c_f32_bf16 v123, s12, v37
    v_dot2c_f32_bf16 v126, v37, v37
    v_dot2c_f32_bf16 v123, s12, v38
    v_dot2c_f32_bf16 v126, v38, v38
    v_dot2c_f32_bf16 v123, s12, v39
    v_dot2c_f32_bf16 v126, v39, v39
    v_lshlrev_b32 v80, 16, v36
    v_and_b32 v81, s13, v36
    v_lshlrev_b32 v82, 16, v37
    v_and_b32 v83, s13, v37
    v_lshlrev_b32 v84, 16, v38
    v_and_b32 v85, s13, v38
    v_lshlrev_b32 v86, 16, v39
    v_and_b32 v87, s13, v39
    s_waitcnt vmcnt(11)
    v_dot2c_f32_bf16 v123, s12, v40
    v_dot2c_f32_bf16 v126, v40, v40
    v_dot2c_f32_bf16 v123, s12, v41
    v_dot2c_f32_bf16 v126, v41, v41
    v_dot2c_f32_bf16 v123, s12, v42
    v_dot2c_f32_bf16 v126, v42, v42
    v_dot2c_f32_bf16 v123, s12, v43
    v_dot2c_f32_bf16 v126, v43, v43
    v_lshlrev_b32 v88, 16, v40
    v_and_b32 v89, s13, v40
    v_lshlrev_b32 v90, 16, v41
    v_and_b32 v91, s13, v41
    v_lshlrev_b32 v92, 16, v42
    v_and_b32 v93, s13, v42
    v_lshlrev_b32 v94, 16, v43
    v_and_b32 v95, s13, v43
    s_waitcnt vmcnt(10)
    v_dot2c_f32_bf16 v123, s12, v44
    v_dot2c_f32_bf16 v126, v44, v44
    v_dot2c_f32_bf16 v123, s12, v45
    v_dot2c_f32_bf16 v126, v45, v45
    v_dot2c_f32_bf16 v123, s12, v46
    v_dot2c_f32_bf16 v126, v46, v46
    v_dot2c_f32_bf16 v123, s12, v47
    v_dot2c_f32_bf16 v126, v47, v47
    v_lshlrev_b32 v96, 16, v44
    v_and_b32 v97, s13, v44
    v_lshlrev_b32 v98, 16, v45
    v_and_b32 v99, s13, v45
    v_lshlrev_b32 v100, 16, v46
    v_and_b32 v101, s13, v46
    v_lshlrev_b32 v102, 16, v47
    v_and_b32 v103, s13, v47
    s_waitcnt vmcnt(9)
    v_dot2c_f32_bf16 v123, s12, v48
    v_dot2c_f32_bf16 v126, v48, v48
    v_dot2c_f32_bf16 v123, s12, v49
    v_dot2c_f32_bf16 v126, v49, v49
    v_dot2c_f32_bf16 v123, s12, v50
    v_dot2c_f32_bf16 v126, v50, v50
    v_dot2c_f32_bf16 v123, s12, v51
    v_dot2c_f32_bf16 v126, v51, v51
    v_lshlrev_b32 v104, 16, v48
    v_and_b32 v105, s13, v48
    v_lshlrev_b32 v106, 16, v49
    v_and_b32 v107, s13, v49
    v_lshlrev_b32 v108, 16, v50
    v_and_b32 v109, s13, v50
    v_lshlrev_b32 v110, 16, v51
    v_and_b32 v111, s13, v51
    s_waitcnt vmcnt(8)
    v_dot2c_f32_bf16 v123, s12, v52
    v_dot2c_f32_bf16 v126, v52, v52
    v_dot2c_f32_bf16 v123, s12, v53
    v_dot2c_f32_bf16 v126, v53, v53
    v_dot2c_f32_bf16 v123, s12, v54
    v_dot2c_f32_bf16 v126, v54, v54
    v_dot2c_f32_bf16 v123, s12, v55
    v_dot2c_f32_bf16 v126, v55, v55
    v_dot2c_f32_bf16 v72, s14, v52
    v_dot2c_f32_bf16 v73, s15, v52
    v_dot2c_f32_bf16 v74, s14, v53
    v_dot2c_f32_bf16 v75, s15, v53
    v_dot2c_f32_bf16 v76, s14, v54
    v_dot2c_f32_bf16 v77, s15, v54
    v_dot2c_f32_bf16 v78, s14, v55
    v_dot2c_f32_bf16 v79, s15, v55
    s_waitcnt vmcnt(7)
    v_dot2c_f32_bf16 v123, s12, v56
    v_dot2c_f32_bf16 v126, v56, v56
    v_dot2c_f32_bf16 v123, s12, v57
    v_dot2c_f32_bf16 v126, v57, v57
    v_dot2c_f32_bf16 v123, s12, v58
    v_dot2c_f32_bf16 v126, v58, v58
    v_dot2c_f32_bf16 v123, s12, v59
    v_dot2c_f32_bf16 v126, v59, v59
    v_dot2c_f32_bf16 v80, s14, v56
    v_dot2c_f32_bf16 v81, s15, v56
    v_dot2c_f32_bf16 v82, s14, v57
    v_dot2c_f32_bf16 v83, s15, v57
    v_dot2c_f32_bf16 v84, s14, v58
    v_dot2c_f32_bf16 v85, s15, v58
    v_dot2c_f32_bf16 v86, s14, v59
    v_dot2c_f32_bf16 v87, s15, v59
    s_waitcnt vmcnt(6)
    v_dot2c_f32_bf16 v123, s12, v60
    v_dot2c_f32_bf16 v126, v60, v60
    v_dot2c_f32_bf16 v123, s12, v61
    v_dot2c_f32_bf16 v126, v61, v61
    v_dot2c_f32_bf16 v123, s12, v62
    v_dot2c_f32_bf16 v126, v62, v62
    v_dot2c_f32_bf16 v123, s12, v63
    v_dot2c_f32_bf16 v126, v63, v63
    v_dot2c_f32_bf16 v88, s14, v60
    v_dot2c_f32_bf16 v89, s15, v60
    v_dot2c_f32_bf16 v90, s14, v61
    v_dot2c_f32_bf16 v91, s15, v61
    v_dot2c_f32_bf16 v92, s14, v62
    v_dot2c_f32_bf16 v93, s15, v62
    v_dot2c_f32_bf16 v94, s14, v63
    v_dot2c_f32_bf16 v95, s15, v63
    s_waitcnt vmcnt(5)
    v_dot2c_f32_bf16 v123, s12, v64
    v_dot2c_f32_bf16 v126, v64, v64
    v_dot2c_f32_bf16 v123, s12, v65
    v_dot2c_f32_bf16 v126, v65, v65
    v_dot2c_f32_bf16 v123, s12, v66
    v_dot2c_f32_bf16 v126, v66, v66
    v_dot2c_f32_bf16 v123, s12, v67
    v_dot2c_f32_bf16 v126, v67, v67
    s_waitcnt vmcnt(4)
    v_dot2c_f32_bf16 v123, s12, v68
    v_dot2c_f32_bf16 v126, v68, v68
    v_dot2c_f32_bf16 v123, s12, v69
    v_dot2c_f32_bf16 v126, v69, v69
    v_dot2c_f32_bf16 v123, s12, v70
    v_dot2c_f32_bf16 v126, v70, v70
    v_dot2c_f32_bf16 v123, s12, v71
    v_dot2c_f32_bf16 v126, v71, v71
    v_dot2c_f32_bf16 v96, s14, v64
    v_dot2c_f32_bf16 v97, s15, v64
    v_dot2c_f32_bf16 v98, s14, v65
    v_add_f32_dpp v123, v123, v123 quad_perm:[1,0,3,2] row_mask:0xf bank_mask:0xf
    v_add_f32_dpp v126, v126, v126 quad_perm:[1,0,3,2] row_mask:0xf bank_mask:0xf
    v_dot2c_f32_bf16 v99, s15, v65
    v_add_f32_dpp v123, v123, v123 quad_perm:[2,3,0,1] row_mask:0xf bank_mask:0xf
    v_add_f32_dpp v126, v126, v126 quad_perm:[2,3,0,1] row_mask:0xf bank_mask:0xf
    v_dot2c_f32_bf16 v100, s14, v66
    v_add_f32_dpp v123, v123, v123 row_half_mirror row_mask:0xf bank_mask:0xf
    v_add_f32_dpp v126, v126, v126 row_half_mirror row_mask:0xf bank_mask:0xf
    v_dot2c_f32_bf16 v101, s15, v66
    v_mul_f32 v123, 0x3acccccd, v123
    v_dot2c_f32_bf16 v102, s14, v67
    v_mul_f32 v9, v123, v123
    v_dot2c_f32_bf16 v103, s15, v67
    v_fmamk_f32 v126, v126, 0x3acccccd, v10
    v_dot2c_f32_bf16 v104, s14, v68
    v_sub_f32 v126, v126, v9
    v_dot2c_f32_bf16 v105, s15, v68
    v_max_f32 v126, v126, v10
    v_dot2c_f32_bf16 v106, s14, v69
    v_rsq_f32 v124, v126
    v_dot2c_f32_bf16 v107, s15, v69
    v_mul_f32 v123, s43, v123
    v_dot2c_f32_bf16 v108, s14, v70
    v_mul_f32 v125, v123, v124
    v_dot2c_f32_bf16 v109, s15, v70
    v_xor_b32 v124, s32, v124
    v_dot2c_f32_bf16 v110, s14, v71
    v_dot2c_f32_bf16 v111, s15, v71
    v_pk_fma_f32 v[72:73], v[72:73], v[124:125], v[124:125] op_sel:[0,0,1] op_sel_hi:[1,0,1]
    v_pk_fma_f32 v[74:75], v[74:75], v[124:125], v[124:125] op_sel:[0,0,1] op_sel_hi:[1,0,1]
    v_pk_fma_f32 v[76:77], v[76:77], v[124:125], v[124:125] op_sel:[0,0,1] op_sel_hi:[1,0,1]
    v_pk_fma_f32 v[78:79], v[78:79], v[124:125], v[124:125] op_sel:[0,0,1] op_sel_hi:[1,0,1]
    v_cvt_pk_bf16_f32 v32, v72, v73
    v_cvt_pk_bf16_f32 v33, v74, v75
    v_cvt_pk_bf16_f32 v34, v76, v77
    v_cvt_pk_bf16_f32 v35, v78, v79
    ds_write_b128 v120, v[32:35] offset:0
    v_pk_fma_f32 v[80:81], v[80:81], v[124:125], v[124:125] op_sel:[0,0,1] op_sel_hi:[1,0,1]
    v_pk_fma_f32 v[82:83], v[82:83], v[124:125], v[124:125] op_sel:[0,0,1] op_sel_hi:[1,0,1]
    v_pk_fma_f32 v[84:85], v[84:85], v[124:125], v[124:125] op_sel:[0,0,1] op_sel_hi:[1,0,1]
    v_pk_fma_f32 v[86:87], v[86:87], v[124:125], v[124:125] op_sel:[0,0,1] op_sel_hi:[1,0,1]
    v_cvt_pk_bf16_f32 v36, v80, v81
    v_cvt_pk_bf16_f32 v37, v82, v83
    v_cvt_pk_bf16_f32 v38, v84, v85
    v_cvt_pk_bf16_f32 v39, v86, v87
    ds_write_b128 v120, v[36:39] offset:2048
    v_pk_fma_f32 v[88:89], v[88:89], v[124:125], v[124:125] op_sel:[0,0,1] op_sel_hi:[1,0,1]
    v_pk_fma_f32 v[90:91], v[90:91], v[124:125], v[124:125] op_sel:[0,0,1] op_sel_hi:[1,0,1]
    v_pk_fma_f32 v[92:93], v[92:93], v[124:125], v[124:125] op_sel:[0,0,1] op_sel_hi:[1,0,1]
    v_pk_fma_f32 v[94:95], v[94:95], v[124:125], v[124:125] op_sel:[0,0,1] op_sel_hi:[1,0,1]
    v_cvt_pk_bf16_f32 v40, v88, v89
    v_cvt_pk_bf16_f32 v41, v90, v91
    v_cvt_pk_bf16_f32 v42, v92, v93
    v_cvt_pk_bf16_f32 v43, v94, v95
    ds_write_b128 v120, v[40:43] offset:4096
    v_pk_fma_f32 v[96:97], v[96:97], v[124:125], v[124:125] op_sel:[0,0,1] op_sel_hi:[1,0,1]
    v_pk_fma_f32 v[98:99], v[98:99], v[124:125], v[124:125] op_sel:[0,0,1] op_sel_hi:[1,0,1]
    v_pk_fma_f32 v[100:101], v[100:101], v[124:125], v[124:125] op_sel:[0,0,1] op_sel_hi:[1,0,1]
    v_pk_fma_f32 v[102:103], v[102:103], v[124:125], v[124:125] op_sel:[0,0,1] op_sel_hi:[1,0,1]
    v_cvt_pk_bf16_f32 v44, v96, v97
    v_cvt_pk_bf16_f32 v45, v98, v99
    v_cvt_pk_bf16_f32 v46, v100, v101
    v_cvt_pk_bf16_f32 v47, v102, v103
    ds_write_b128 v120, v[44:47] offset:6144
    v_pk_fma_f32 v[104:105], v[104:105], v[124:125], v[124:125] op_sel:[0,0,1] op_sel_hi:[1,0,1]
    v_pk_fma_f32 v[106:107], v[106:107], v[124:125], v[124:125] op_sel:[0,0,1] op_sel_hi:[1,0,1]
    v_pk_fma_f32 v[108:109], v[108:109], v[124:125], v[124:125] op_sel:[0,0,1] op_sel_hi:[1,0,1]
    v_pk_fma_f32 v[110:111], v[110:111], v[124:125], v[124:125] op_sel:[0,0,1] op_sel_hi:[1,0,1]
    v_cvt_pk_bf16_f32 v48, v104, v105
    v_cvt_pk_bf16_f32 v49, v106, v107
    v_cvt_pk_bf16_f32 v50, v108, v109
    v_cvt_pk_bf16_f32 v51, v110, v111
    ds_write_b128 v120, v[48:51] offset:8192
    s_waitcnt lgkmcnt(0)
    s_barrier
    ds_read_b128 v[32:35], v121 offset:0
    ds_read_b128 v[36:39], v122 offset:1024
    ds_read_b128 v[40:43], v121 offset:2048
    ds_read_b128 v[44:47], v122 offset:3072
    ds_read_b128 v[48:51], v121 offset:4096
    ds_read_b128 v[52:55], v122 offset:5120
    ds_read_b128 v[56:59], v121 offset:6144
    ds_read_b128 v[60:63], v122 offset:7168
    ds_read_b128 v[64:67], v121 offset:8192
    ds_read_b128 v[68:71], v122 offset:9216
    v_xor_b32 v25, 10240, v121
    v_xor_b32 v26, 10240, v122
    s_lshl_b32 s28, s33, 3
    s_mul_i32 s29, s53, 6
    s_mul_i32 s44, s33, 3072
    s_add_u32 s44, s44, 28672
    s_mul_i32 s50, s40, -6144
    s_add_u32 s50, s50, 3072
    v_lshrrev_b32 v5, 4, v4
    v_and_b32 v3, 0xf0, v18
    v_lshl_add_u32 v253, v4, 3, s44
    v_add_u32 v173, s50, v253
    v_bfe_u32 v9, v4, 2, 2
    v_mul_u32_u24 v9, 160, v9
    v_and_b32 v10, 3, v4
    v_lshl_add_u32 v9, v10, 3, v9
    v_and_b32 v2, 8, v4
    v_mul_u32_u24 v2, 40, v2
    v_add3_u32 v6, s28, v5, 0
    v_mul_u32_u24 v7, 52, v6
    v_lshrrev_b32 v7, 8, v7
    v_mad_i32_i24 v6, v7, -5, v6
    v_add_u32 v8, s29, v7
    v_lshrrev_b32 v10, 2, v8
    v_lshl_add_u32 v10, v10, 12, v3
    v_lshl_add_u32 v10, v8, 8, v10
    s_waitcnt lgkmcnt(9)
    v_mfma_f32_16x16x32_bf16 v[104:107], v[32:35], v[232:235], 0
    s_waitcnt lgkmcnt(8)
    v_lshl_add_u32 v120, v6, 10, v10
    v_lshl_add_u32 v6, v6, 5, v9
    v_mfma_f32_16x16x32_bf16 v[104:107], v[36:39], v[236:239], v[104:107]
    s_waitcnt lgkmcnt(7)
    v_mul_u32_u24 v8, 1280, v7
    v_bfe_i32 v7, 36, v7, 1
    v_mfma_f32_16x16x32_bf16 v[104:107], v[40:43], v[240:243], v[104:107]
    s_waitcnt lgkmcnt(6)
    v_and_b32 v10, v7, v2
    v_add3_u32 v123, v6, v8, v10
    v_mfma_f32_16x16x32_bf16 v[104:107], v[44:47], v[244:247], v[104:107]
    s_waitcnt lgkmcnt(5)
    v_and_b32 v10, 320, v7
    v_sub_u32 v124, v123, v10
    v_mfma_f32_16x16x32_bf16 v[104:107], v[48:51], v[248:251], v[104:107]
    s_add_u32 m0, s60, 40960
    v_add3_u32 v6, s28, v5, 4
    v_min_u32 v6, 29, v6
    v_mfma_f32_16x16x32_bf16 v[72:75], v[48:51], v[208:211], 0
    s_add_u32 s59, s58, 4096
    v_mul_u32_u24 v7, 52, v6
    v_lshrrev_b32 v7, 8, v7
    v_mfma_f32_16x16x32_bf16 v[72:75], v[44:47], v[204:207], v[72:75]
    s_mul_i32 s43, s52, 245760
    v_mad_i32_i24 v6, v7, -5, v6
    v_add_u32 v8, s29, v7
    v_mfma_f32_16x16x32_bf16 v[72:75], v[40:43], v[200:203], v[72:75]
    s_add_u32 s43, s43, 2883584
    v_lshrrev_b32 v10, 2, v8
    v_lshl_add_u32 v10, v10, 12, v3
    v_mfma_f32_16x16x32_bf16 v[72:75], v[36:39], v[196:199], v[72:75]
    buffer_load_dwordx4 v19, s[8:11], s59 offen offset:0 lds
    v_lshl_add_u32 v10, v8, 8, v10
    v_mfma_f32_16x16x32_bf16 v[72:75], v[32:35], v[192:195], v[72:75]
    s_lshl1_add_u32 s30, s35, s41
    v_lshl_add_u32 v127, v6, 10, v10
    v_lshl_add_u32 v6, v6, 5, v9
    v_mfma_f32_16x16x32_bf16 v[88:91], v[32:35], v[212:215], 0
    s_lshl_b32 s30, s30, 6
    ds_read_b128 v[32:35], v25 offset:0
    v_mul_u32_u24 v8, 1280, v7
    v_mfma_f32_16x16x32_bf16 v[88:91], v[36:39], v[216:219], v[88:91]
    ds_read_b128 v[36:39], v26 offset:1024
    v_bfe_i32 v7, 36, v7, 1
    v_mfma_f32_16x16x32_bf16 v[88:91], v[40:43], v[220:223], v[88:91]
    s_add_u32 s30, s30, s34
    ds_read_b128 v[40:43], v25 offset:2048
    v_and_b32 v10, v7, v2
    v_mfma_f32_16x16x32_bf16 v[88:91], v[44:47], v[224:227], v[88:91]
    ds_read_b128 v[44:47], v26 offset:3072
    v_add3_u32 v125, v6, v8, v10
    v_mfma_f32_16x16x32_bf16 v[88:91], v[48:51], v[228:231], v[88:91]
    s_waitcnt lgkmcnt(4)
    ds_read_b128 v[48:51], v25 offset:4096
    v_and_b32 v10, 320, v7
    v_mfma_f32_16x16x32_bf16 v[112:115], v[52:55], v[232:235], 0
    buffer_load_dwordx4 v20, s[8:11], s59 offen offset:1024 lds
    v_sub_u32 v126, v125, v10
    v_mfma_f32_16x16x32_bf16 v[112:115], v[56:59], v[236:239], v[112:115]
    s_lshl1_add_u32 s31, s30, s40
    v_lshrrev_b32 v6, 2, v4
    v_and_b32 v7, 3, v4
    v_mfma_f32_16x16x32_bf16 v[112:115], v[60:63], v[240:243], v[112:115]
    s_lshl_b32 s31, s31, 6
    v_lshlrev_b32 v8, 16, v6
    v_lshl_add_u32 v27, v7, 4, v8
    v_mfma_f32_16x16x32_bf16 v[112:115], v[64:67], v[244:247], v[112:115]
    v_mul_u32_u24 v7, 320, v7
    v_lshl_add_u32 v7, v6, 4, v7
    v_mfma_f32_16x16x32_bf16 v[112:115], v[68:71], v[248:251], v[112:115]
    buffer_load_dwordx4 v21, s[8:11], s59 offen offset:2048 lds
    s_add_u32 m0, s60, 53248
    v_mfma_f32_16x16x32_bf16 v[80:83], v[68:71], v[208:211], 0
    s_lshl_b32 s32, s40, 20
    v_add_u32 v175, s44, v7
    v_lshl_add_u32 v7, v5, 6, v18
    v_mfma_f32_16x16x32_bf16 v[80:83], v[64:67], v[204:207], v[80:83]
    v_add_u32 v174, s44, v7
    v_lshl_add_u32 v7, v3, 1, s44
    v_mfma_f32_16x16x32_bf16 v[80:83], v[60:63], v[200:203], v[80:83]
    s_cmp_eq_u32 s49, 0
    s_cbranch_scc1 L_even
L_odd:
    s_add_u32 s59, s58, 200704
    v_mfma_f32_16x16x32_bf16 v[80:83], v[56:59], v[196:199], v[80:83]
    s_add_u32 s31, s31, s32
    v_fmac_f32_dpp v104, v112, v12 row_ror:8 row_mask:0xf bank_mask:0xf
    v_fmac_f32_dpp v105, v113, v12 row_ror:8 row_mask:0xf bank_mask:0xf
    v_mfma_f32_16x16x32_bf16 v[80:83], v[52:55], v[192:195], v[80:83]
    s_waitcnt lgkmcnt(0)
    v_fmac_f32_dpp v106, v114, v12 row_ror:8 row_mask:0xf bank_mask:0xf
    v_fmac_f32_dpp v107, v115, v12 row_ror:8 row_mask:0xf bank_mask:0xf
    v_mfma_f32_16x16x32_bf16 v[96:99], v[52:55], v[212:215], 0
    s_add_u32 s13, s31, 262144
    ds_read_b128 v[52:55], v26 offset:5120
    v_cvt_pk_f16_f32 v136, v104, v105
    v_mfma_f32_16x16x32_bf16 v[96:99], v[56:59], v[216:219], v[96:99]
    ds_read_b128 v[56:59], v25 offset:6144
    v_cvt_pk_f16_f32 v137, v106, v107
    v_mfma_f32_16x16x32_bf16 v[96:99], v[60:63], v[220:223], v[96:99]
    s_xor_b32 s31, s31, 0x100000
    ds_read_b128 v[60:63], v26 offset:7168
    v_lshl_add_u32 v252, v5, 3, v7
    v_mfma_f32_16x16x32_bf16 v[96:99], v[64:67], v[224:227], v[96:99]
    ds_read_b128 v[64:67], v25 offset:8192
    v_fmac_f32_dpp v72, v80, v12 row_ror:8 row_mask:0xf bank_mask:0xf
    v_mfma_f32_16x16x32_bf16 v[96:99], v[68:71], v[228:231], v[96:99]
    ds_read_b128 v[68:71], v26 offset:9216
    v_fmac_f32_dpp v73, v81, v12 row_ror:8 row_mask:0xf bank_mask:0xf
    v_mfma_f32_16x16x32_bf16 v[76:79], v[32:35], v[192:195], 0
    s_add_u32 s14, s31, 262144
    ds_write_b64 v253, v[136:137]
    v_mfma_f32_16x16x32_bf16 v[76:79], v[36:39], v[196:199], v[76:79]
    buffer_load_dwordx4 v19, s[8:11], s59 offen offset:0 lds
    v_fmac_f32_dpp v74, v82, v12 row_ror:8 row_mask:0xf bank_mask:0xf
    v_mfma_f32_16x16x32_bf16 v[76:79], v[40:43], v[200:203], v[76:79]
    s_lshl_b32 s30, s30, 6
    v_fmac_f32_dpp v75, v83, v12 row_ror:8 row_mask:0xf bank_mask:0xf
    v_cvt_pk_f16_f32 v128, v72, v73
    v_mfma_f32_16x16x32_bf16 v[76:79], v[44:47], v[204:207], v[76:79]
    v_fmac_f32_dpp v88, v96, v12 row_ror:8 row_mask:0xf bank_mask:0xf
    v_fmac_f32_dpp v89, v97, v12 row_ror:8 row_mask:0xf bank_mask:0xf
    v_mfma_f32_16x16x32_bf16 v[76:79], v[48:51], v[208:211], v[76:79]
    s_waitcnt lgkmcnt(1)
    v_fmac_f32_dpp v90, v98, v12 row_ror:8 row_mask:0xf bank_mask:0xf
    v_cvt_pk_f16_f32 v129, v74, v75
    v_mfma_f32_16x16x32_bf16 v[84:87], v[52:55], v[192:195], 0
    s_waitcnt lgkmcnt(0)
    s_barrier
    buffer_load_dwordx4 v20, s[8:11], s59 offen offset:1024 lds
    v_mfma_f32_16x16x32_bf16 v[84:87], v[56:59], v[196:199], v[84:87]
    s_lshr_b32 s32, s32, 2
    ds_read_b64 v[138:139], v173
    v_fmac_f32_dpp v91, v99, v12 row_ror:8 row_mask:0xf bank_mask:0xf
    v_mfma_f32_16x16x32_bf16 v[84:87], v[60:63], v[200:203], v[84:87]
    s_add_u32 s30, s30, s32
    v_xor_b32_dpp v140, v128, v11 row_ror:8 row_mask:0xf bank_mask:0xf
    v_cvt_pk_f16_f32 v132, v88, v89
    v_mfma_f32_16x16x32_bf16 v[84:87], v[64:67], v[204:207], v[84:87]
    v_cvt_pk_f16_f32 v133, v90, v91
    v_xor_b32_dpp v141, v129, v11 row_ror:8 row_mask:0xf bank_mask:0xf
    v_mfma_f32_16x16x32_bf16 v[84:87], v[68:71], v[208:211], v[84:87]
    buffer_load_dwordx4 v21, s[8:11], s59 offen offset:2048 lds
    v_xor_b32_dpp v144, v132, v11 row_ror:8 row_mask:0xf bank_mask:0xf
    v_mfma_f32_16x16x32_bf16 v[92:95], v[32:35], v[212:215], 0
    s_add_u32 s15, s30, 2359296
    v_xor_b32_dpp v145, v133, v11 row_ror:8 row_mask:0xf bank_mask:0xf
    v_lshrrev_b32 v6, 3, v4
    v_mfma_f32_16x16x32_bf16 v[92:95], v[36:39], v[216:219], v[92:95]
    s_waitcnt lgkmcnt(0)
    v_xor_b32_dpp v148, v136, v11 row_ror:8 row_mask:0xf bank_mask:0xf
    v_xor_b32_dpp v149, v137, v11 row_ror:8 row_mask:0xf bank_mask:0xf
    v_mfma_f32_16x16x32_bf16 v[92:95], v[40:43], v[220:223], v[92:95]
    s_waitcnt vmcnt(8)
    s_barrier
    v_xor_b32_dpp v150, v138, v11 row_ror:8 row_mask:0xf bank_mask:0xf
    v_mfma_f32_16x16x32_bf16 v[92:95], v[44:47], v[224:227], v[92:95]
    ds_read_b64_tr_b16 a[232:233], v123 offset:20480
    v_fmac_f32_dpp v76, v84, v12 row_ror:8 row_mask:0xf bank_mask:0xf
    v_mfma_f32_16x16x32_bf16 v[92:95], v[48:51], v[228:231], v[92:95]
    ds_read_b64_tr_b16 a[234:235], v124 offset:21120
    v_fmac_f32_dpp v77, v85, v12 row_ror:8 row_mask:0xf bank_mask:0xf
    v_mfma_f32_16x16x32_bf16 v[100:103], v[52:55], v[212:215], 0
    ds_read_b64_tr_b16 a[236:237], v125 offset:20480
    v_fmac_f32_dpp v78, v86, v12 row_ror:8 row_mask:0xf bank_mask:0xf
    v_mfma_f32_16x16x32_bf16 v[100:103], v[56:59], v[216:219], v[100:103]
    ds_read_b64_tr_b16 a[238:239], v126 offset:21120
    v_fmac_f32_dpp v79, v87, v12 row_ror:8 row_mask:0xf bank_mask:0xf
    v_mfma_f32_16x16x32_bf16 v[100:103], v[60:63], v[220:223], v[100:103]
    v_cvt_pk_f16_f32 v130, v76, v77
    v_xor_b32_dpp v151, v139, v11 row_ror:8 row_mask:0xf bank_mask:0xf
    v_mfma_f32_16x16x32_bf16 v[100:103], v[64:67], v[224:227], v[100:103]
    v_cvt_pk_f16_f32 v131, v78, v79
    v_xor_b32_dpp v142, v130, v11 row_ror:8 row_mask:0xf bank_mask:0xf
    v_mfma_f32_16x16x32_bf16 v[100:103], v[68:71], v[228:231], v[100:103]
    v_xor_b32_dpp v143, v131, v11 row_ror:8 row_mask:0xf bank_mask:0xf
    v_mul_u32_u24 v6, 32704, v6
    v_mfma_f32_16x16x32_f16 v[168:171], v[136:139], v[176:179], 0
    v_lshl_add_u32 v28, v4, 3, v6
    v_mfma_f32_16x16x32_f16 v[168:171], v[148:151], v[180:183], v[168:171]
    s_waitcnt lgkmcnt(0)
    buffer_store_dwordx4 a[232:235], v120, s[24:27], s43 offen sc1
    v_mfma_f32_16x16x32_f16 v[152:155], v[128:131], v[176:179], 0
    v_mfma_f32_16x16x32_f16 v[152:155], v[140:143], v[180:183], v[152:155]
    v_fmac_f32_dpp v92, v100, v12 row_ror:8 row_mask:0xf bank_mask:0xf
    v_fmac_f32_dpp v93, v101, v12 row_ror:8 row_mask:0xf bank_mask:0xf
    v_mfma_f32_16x16x32_f16 v[156:159], v[128:131], v[184:187], 0
    v_fmac_f32_dpp v94, v102, v12 row_ror:8 row_mask:0xf bank_mask:0xf
    v_fmac_f32_dpp v95, v103, v12 row_ror:8 row_mask:0xf bank_mask:0xf
    v_mfma_f32_16x16x32_f16 v[156:159], v[140:143], v[188:191], v[156:159]
    s_branch L_segend
L_even:
    s_add_u32 s59, s58, 200704
    v_mfma_f32_16x16x32_bf16 v[80:83], v[56:59], v[196:199], v[80:83]
    s_add_u32 s31, s31, s32
    v_fmac_f32 v104, v112, v12
    v_fmac_f32 v105, v113, v12
    v_mfma_f32_16x16x32_bf16 v[80:83], v[52:55], v[192:195], v[80:83]
    s_waitcnt lgkmcnt(0)
    v_fmac_f32 v106, v114, v12
    v_fmac_f32 v107, v115, v12
    v_mfma_f32_16x16x32_bf16 v[96:99], v[52:55], v[212:215], 0
    s_add_u32 s13, s31, 262144
    ds_read_b128 v[52:55], v26 offset:5120
    v_cvt_pk_f16_f32 v136, v104, v105
    v_mfma_f32_16x16x32_bf16 v[96:99], v[56:59], v[216:219], v[96:99]
    ds_read_b128 v[56:59], v25 offset:6144
    v_cvt_pk_f16_f32 v137, v106, v107
    v_mfma_f32_16x16x32_bf16 v[96:99], v[60:63], v[220:223], v[96:99]
    s_xor_b32 s31, s31, 0x100000
    ds_read_b128 v[60:63], v26 offset:7168
    v_lshl_add_u32 v252, v5, 3, v7
    v_mfma_f32_16x16x32_bf16 v[96:99], v[64:67], v[224:227], v[96:99]
    ds_read_b128 v[64:67], v25 offset:8192
    v_fmac_f32 v72, v80, v12
    v_mfma_f32_16x16x32_bf16 v[96:99], v[68:71], v[228:231], v[96:99]
    ds_read_b128 v[68:71], v26 offset:9216
    v_fmac_f32 v73, v81, v12
    v_mfma_f32_16x16x32_bf16 v[76:79], v[32:35], v[192:195], 0
    s_add_u32 s14, s31, 262144
    ds_write_b64 v253, v[136:137]
    v_mfma_f32_16x16x32_bf16 v[76:79], v[36:39], v[196:199], v[76:79]
    buffer_load_dwordx4 v19, s[8:11], s59 offen offset:0 lds
    v_fmac_f32 v74, v82, v12
    v_mfma_f32_16x16x32_bf16 v[76:79], v[40:43], v[200:203], v[76:79]
    s_lshl_b32 s30, s30, 6
    v_fmac_f32 v75, v83, v12
    v_cvt_pk_f16_f32 v128, v72, v73
    v_mfma_f32_16x16x32_bf16 v[76:79], v[44:47], v[204:207], v[76:79]
    v_fmac_f32 v88, v96, v12
    v_fmac_f32 v89, v97, v12
    v_mfma_f32_16x16x32_bf16 v[76:79], v[48:51], v[208:211], v[76:79]
    s_waitcnt lgkmcnt(1)
    v_fmac_f32 v90, v98, v12
    v_cvt_pk_f16_f32 v129, v74, v75
    v_mfma_f32_16x16x32_bf16 v[84:87], v[52:55], v[192:195], 0
    s_waitcnt lgkmcnt(0)
    s_barrier
    buffer_load_dwordx4 v20, s[8:11], s59 offen offset:1024 lds
    v_mfma_f32_16x16x32_bf16 v[84:87], v[56:59], v[196:199], v[84:87]
    s_lshr_b32 s32, s32, 2
    ds_read_b64 v[138:139], v173
    v_fmac_f32 v91, v99, v12
    v_mfma_f32_16x16x32_bf16 v[84:87], v[60:63], v[200:203], v[84:87]
    s_add_u32 s30, s30, s32
    v_xor_b32_dpp v140, v128, v11 row_ror:8 row_mask:0xf bank_mask:0xf
    v_cvt_pk_f16_f32 v132, v88, v89
    v_mfma_f32_16x16x32_bf16 v[84:87], v[64:67], v[204:207], v[84:87]
    v_cvt_pk_f16_f32 v133, v90, v91
    v_xor_b32_dpp v141, v129, v11 row_ror:8 row_mask:0xf bank_mask:0xf
    v_mfma_f32_16x16x32_bf16 v[84:87], v[68:71], v[208:211], v[84:87]
    buffer_load_dwordx4 v21, s[8:11], s59 offen offset:2048 lds
    v_xor_b32_dpp v144, v132, v11 row_ror:8 row_mask:0xf bank_mask:0xf
    v_mfma_f32_16x16x32_bf16 v[92:95], v[32:35], v[212:215], 0
    s_add_u32 s15, s30, 2359296
    v_xor_b32_dpp v145, v133, v11 row_ror:8 row_mask:0xf bank_mask:0xf
    v_lshrrev_b32 v6, 3, v4
    v_mfma_f32_16x16x32_bf16 v[92:95], v[36:39], v[216:219], v[92:95]
    s_waitcnt lgkmcnt(0)
    v_xor_b32_dpp v148, v136, v11 row_ror:8 row_mask:0xf bank_mask:0xf
    v_xor_b32_dpp v149, v137, v11 row_ror:8 row_mask:0xf bank_mask:0xf
    v_mfma_f32_16x16x32_bf16 v[92:95], v[40:43], v[220:223], v[92:95]
    s_waitcnt vmcnt(8)
    s_barrier
    v_xor_b32_dpp v150, v138, v11 row_ror:8 row_mask:0xf bank_mask:0xf
    v_mfma_f32_16x16x32_bf16 v[92:95], v[44:47], v[224:227], v[92:95]
    ds_read_b64_tr_b16 a[232:233], v123 offset:20480
    v_fmac_f32 v76, v84, v12
    v_mfma_f32_16x16x32_bf16 v[92:95], v[48:51], v[228:231], v[92:95]
    ds_read_b64_tr_b16 a[234:235], v124 offset:21120
    v_fmac_f32 v77, v85, v12
    v_mfma_f32_16x16x32_bf16 v[100:103], v[52:55], v[212:215], 0
    ds_read_b64_tr_b16 a[236:237], v125 offset:20480
    v_fmac_f32 v78, v86, v12
    v_mfma_f32_16x16x32_bf16 v[100:103], v[56:59], v[216:219], v[100:103]
    ds_read_b64_tr_b16 a[238:239], v126 offset:21120
    v_fmac_f32 v79, v87, v12
    v_mfma_f32_16x16x32_bf16 v[100:103], v[60:63], v[220:223], v[100:103]
    v_cvt_pk_f16_f32 v130, v76, v77
    v_xor_b32_dpp v151, v139, v11 row_ror:8 row_mask:0xf bank_mask:0xf
    v_mfma_f32_16x16x32_bf16 v[100:103], v[64:67], v[224:227], v[100:103]
    v_cvt_pk_f16_f32 v131, v78, v79
    v_xor_b32_dpp v142, v130, v11 row_ror:8 row_mask:0xf bank_mask:0xf
    v_mfma_f32_16x16x32_bf16 v[100:103], v[68:71], v[228:231], v[100:103]
    v_xor_b32_dpp v143, v131, v11 row_ror:8 row_mask:0xf bank_mask:0xf
    v_mul_u32_u24 v6, 32704, v6
    v_mfma_f32_16x16x32_f16 v[168:171], v[136:139], v[176:179], 0
    v_lshl_add_u32 v28, v4, 3, v6
    v_mfma_f32_16x16x32_f16 v[168:171], v[148:151], v[180:183], v[168:171]
    s_waitcnt lgkmcnt(0)
    buffer_store_dwordx4 a[232:235], v120, s[24:27], s43 offen sc1
    v_mfma_f32_16x16x32_f16 v[152:155], v[128:131], v[176:179], 0
    v_mfma_f32_16x16x32_f16 v[152:155], v[140:143], v[180:183], v[152:155]
    v_fmac_f32 v92, v100, v12
    v_fmac_f32 v93, v101, v12
    v_mfma_f32_16x16x32_f16 v[156:159], v[128:131], v[184:187], 0
    v_fmac_f32 v94, v102, v12
    v_fmac_f32 v95, v103, v12
    v_mfma_f32_16x16x32_f16 v[156:159], v[140:143], v[188:191], v[156:159]
    s_nop 0
L_segend:
    v_cvt_pk_f16_f32 v134, v92, v93
    v_cvt_pk_f16_f32 v135, v94, v95
    s_nop 0
    v_xor_b32_dpp v146, v134, v11 row_ror:8 row_mask:0xf bank_mask:0xf
    v_xor_b32_dpp v147, v135, v11 row_ror:8 row_mask:0xf bank_mask:0xf
    v_cvt_pk_f16_f32 v200, v168, v169
    v_cvt_pk_f16_f32 v201, v170, v171
    v_mfma_f32_16x16x32_f16 v[160:163], v[132:135], v[176:179], 0
    ds_write_b64 v252, v[200:201] offset:2432
    v_mfma_f32_16x16x32_f16 v[160:163], v[144:147], v[180:183], v[160:163]
    ds_read_b64 v[212:213], v253 offset:2432
    v_mfma_f32_16x16x32_f16 v[164:167], v[132:135], v[184:187], 0
    v_cvt_pk_f16_f32 v192, v152, v153
    v_cvt_pk_f16_f32 v193, v154, v155
    v_mfma_f32_16x16x32_f16 v[164:167], v[144:147], v[188:191], v[164:167]
    v_cvt_pk_f16_f32 v196, v156, v157
    v_cvt_pk_f16_f32 v197, v158, v159
    buffer_store_dwordx4 a[236:239], v127, s[24:27], s43 offen sc1
    v_cvt_pk_f16_f32 v194, v160, v161
    v_cvt_pk_f16_f32 v195, v162, v163
    ds_write_b128 v174, v[192:195]
    ds_read_b128 v[204:207], v175
    s_nop 0
    v_cvt_pk_f16_f32 v198, v164, v165
    v_cvt_pk_f16_f32 v199, v166, v167
    ds_write_b128 v174, v[196:199] offset:1216
    ds_read_b128 v[208:211], v175 offset:1216
    s_waitcnt lgkmcnt(4)
    buffer_store_dwordx2 v[212:213], v28, s[24:27], s15 offen sc1
    s_waitcnt lgkmcnt(2)
    buffer_store_dwordx4 v[204:207], v27, s[24:27], s13 offen sc1
    s_waitcnt lgkmcnt(0)
    buffer_store_dwordx4 v[208:211], v27, s[24:27], s14 offen sc1
    s_branch L_al
.p2align 12
L_al:
    s_sub_u32 s28, 2048, s46
    s_sub_u32 s29, 32, s46
    s_cmp_eq_u32 s39, 0
    s_cselect_b32 s13, s45, s28
    s_cselect_b32 s14, 32, -32
    s_cselect_b32 s15, s45, s29
    s_cmp_eq_u32 s15, 0
    s_cselect_b64 s[16:17], -1, 0
    s_lshl_b32 s28, s33, 4
    v_and_b32 v110, 15, v4
    v_add_u32 v110, s28, v110
    v_lshrrev_b32 v5, 4, v110
    v_and_b32 v6, 7, v110
    v_lshl_add_u32 v5, v5, 3, v6
    v_and_b32 v108, 8, v110
    v_cmp_ne_u32 vcc, 0, v108
    v_sub_u32 v6, 64, v5
    v_lshrrev_b32 v108, 6, v6
    v_lshrrev_b32 v6, v108, v6
    v_cndmask_b32 v5, v5, v6, vcc
    v_cndmask_b32 v108, v110, v5, s[16:17]
    v_mul_i32_i24 v108, s14, v108
    v_add_u32 v108, s13, v108
    v_sub_u32 v109, 2048, v108
    v_and_b32 v109, 2047, v109
    v_and_b32 v5, 60, v4
    ds_bpermute_b32 v66, v5, v108
    ds_bpermute_b32 v67, v5, v109
    s_mul_i32 s28, s47, 160
    s_lshl_b32 s29, s49, 2
    s_sub_u32 s29, s28, s29
    s_add_u32 s18, s29, 4
    s_sub_u32 s19, 1152, s28
    s_mul_i32 s44, s33, 5120
    v_lshrrev_b32 v112, 4, v4
    v_and_b32 v113, 1, v112
    v_mul_u32_u24 v69, 1280, v109
    s_cmp_eq_u32 s38, 3
    s_cselect_b32 s43, 0, 0x7fffffff
    v_and_b32 v5, 0x30, v18
    v_and_b32 v6, 2, v4
    v_cmp_ne_u32 vcc, 0, v6
    v_and_b32 v6, 0xf0, v18
    v_lshl_add_u32 v6, v6, 2, s44
    v_lshl_add_u32 v71, v113, 4, v6
    v_lshl_add_u32 v6, v113, 5, v6
    v_lshrrev_b32 v7, 5, v4
    v_lshl_add_u32 v70, v7, 10, v6
    s_movk_i32 s28, 1280
    s_waitcnt lgkmcnt(1)
    v_mad_u32_u24 v66, v66, s28, v5
    s_waitcnt lgkmcnt(0)
    v_mad_u32_u24 v67, v67, s28, v5
    s_add_u32 s28, s18, 128
    s_sub_u32 s29, s19, 64
    v_add_u32 v5, s28, v66
    v_add_u32 v6, s29, v67
    v_cndmask_b32 v68, v5, v6, vcc
    s_waitcnt vmcnt(11)
    v_readfirstlane_b32 s52, v172
    s_add_u32 m0, s44, 0
    s_nop 0
    buffer_load_dwordx4 v66, s[4:7], s18 offen offset:0 lds
    s_add_u32 m0, s44, 960
    s_nop 0
    buffer_load_dwordx4 v66, s[4:7], s18 offen offset:64 lds
    s_add_u32 m0, s44, 2048
    s_nop 0
    buffer_load_dwordx4 v67, s[4:7], s19 offen offset:0 lds
    s_add_u32 m0, s44, 3008
    s_nop 0
    buffer_load_dwordx4 v67, s[4:7], s19 offen offset:64 lds
    s_add_u32 m0, s44, 4096
    s_nop 0
    buffer_load_dwordx4 v68, s[4:7], 0 offen offset:0 lds
    buffer_load_ushort v64, v69, s[4:7], s43 offen
    s_lshr_b32 s29, s48, 3
    s_lshl3_add_u32 s32, s35, s29
    s_lshl_b32 s32, s32, 11
    s_and_b32 s29, s48, 7
    s_lshl2_add_u32 s32, s29, s32
    s_mul_i32 s52, s52, 0x9E3779B1
    s_add_u32 s52, s52, 0x7F4A7C15
    s_mov_b32 s53, s52
    v_mov_b32 v78, s52
    s_lshl_b32 s29, s33, 9
    s_add_u32 s32, s32, s29
    s_add_u32 s92, s24, s32
    s_addc_u32 s93, s25, 0
    s_mov_b64 s[88:89], s[52:53]
    s_mov_b64 s[90:91], s[52:53]
    s_lshr_b32 s28, s38, 1
    s_lshl2_add_u32 s28, s28, s33
    s_lshl_b32 s28, s28, 5
    s_add_u32 s28, s28, s45
    s_lshl_b32 s28, s28, 7
    s_add_u32 s54, s24, s28
    s_addc_u32 s55, s25, 0
    v_cvt_f32_u32 v7, v108
    v_mul_f32 v7, 0x3a000000, v7
    v_lshlrev_b32 v8, 2, v112
    v_cvt_f32_u32 v8, v8
    v_mul_f32 v8, v7, v8
    v_fmamk_f32 v144, v7, 0x0, v8
    v_fmamk_f32 v145, v7, 0x3f800000, v8
    v_fmamk_f32 v146, v7, 0x40000000, v8
    v_fmamk_f32 v147, v7, 0x40400000, v8
    s_waitcnt vmcnt(6)
    s_barrier
    s_atomic_swap s88, s[92:93], 0 glc
    s_atomic_swap s89, s[92:93], 128 glc
    s_atomic_swap s90, s[92:93], 256 glc
    s_atomic_swap s91, s[92:93], 384 glc
    v_fmamk_f32 v148, v7, 0x41800000, v8
    s_add_u32 m0, s60, 65536
    s_add_u32 s59, s58, 397312
    buffer_load_dwordx4 v19, s[8:11], s59 offen offset:0 lds
    buffer_load_dwordx4 v20, s[8:11], s59 offen offset:1024 lds
    buffer_load_dwordx4 v21, s[8:11], s59 offen offset:2048 lds
    v_fmamk_f32 v149, v7, 0x41880000, v8
    v_fmamk_f32 v150, v7, 0x41900000, v8
    v_fmamk_f32 v151, v7, 0x41980000, v8
    v_sin_f32 v152, v144
    v_sin_f32 v153, v145
    v_sin_f32 v154, v146
    v_sin_f32 v155, v147
    v_sin_f32 v156, v148
    v_sin_f32 v157, v149
    v_sin_f32 v158, v150
    v_sin_f32 v159, v151
    v_cos_f32 v144, v144
    v_cos_f32 v145, v145
    v_cos_f32 v146, v146
    v_cos_f32 v147, v147
    v_cos_f32 v148, v148
    v_cos_f32 v149, v149
    v_cos_f32 v150, v150
    v_cos_f32 v151, v151
    v_cvt_pk_f16_f32 v136, v152, v153
    v_cvt_pk_f16_f32 v137, v154, v155
    v_cvt_pk_f16_f32 v138, v156, v157
    v_cvt_pk_f16_f32 v139, v158, v159
    v_cvt_pk_f16_f32 v128, v144, v145
    v_cvt_pk_f16_f32 v129, v146, v147
    v_cvt_pk_f16_f32 v130, v148, v149
    v_cvt_pk_f16_f32 v131, v150, v151
    v_fmamk_f32 v144, v7, 0x42000000, v8
    v_fmamk_f32 v145, v7, 0x42040000, v8
    v_fmamk_f32 v146, v7, 0x42080000, v8
    s_add_u32 m0, s60, 77824
    s_add_u32 s59, s58, 593920
    buffer_load_dwordx4 v19, s[8:11], s59 offen offset:0 lds
    buffer_load_dwordx4 v20, s[8:11], s59 offen offset:1024 lds
    buffer_load_dwordx4 v21, s[8:11], s59 offen offset:2048 lds
    v_fmamk_f32 v147, v7, 0x420c0000, v8
    v_fmamk_f32 v148, v7, 0x42400000, v8
    v_fmamk_f32 v149, v7, 0x42440000, v8
    v_fmamk_f32 v150, v7, 0x42480000, v8
    v_fmamk_f32 v151, v7, 0x424c0000, v8
    v_sin_f32 v152, v144
    v_sin_f32 v153, v145
    v_sin_f32 v154, v146
    v_sin_f32 v155, v147
    v_sin_f32 v156, v148
    v_sin_f32 v157, v149
    v_sin_f32 v158, v150
    v_sin_f32 v159, v151
    v_cos_f32 v144, v144
    v_cos_f32 v145, v145
    v_cos_f32 v146, v146
    v_cos_f32 v147, v147
    v_cos_f32 v148, v148
    v_cos_f32 v149, v149
    v_cos_f32 v150, v150
    v_cos_f32 v151, v151
    v_cvt_pk_f16_f32 v140, v152, v153
    v_cvt_pk_f16_f32 v141, v154, v155
    v_cvt_pk_f16_f32 v142, v156, v157
    v_cvt_pk_f16_f32 v143, v158, v159
    v_cvt_pk_f16_f32 v132, v144, v145
    v_cvt_pk_f16_f32 v133, v146, v147
    v_cvt_pk_f16_f32 v134, v148, v149
    v_cvt_pk_f16_f32 v135, v150, v151
    v_lshrrev_b32 v7, 3, v4
    v_and_b32 v7, 6, v7
    s_add_u32 m0, s60, 90112
    s_add_u32 s59, s58, 790528
    buffer_load_dwordx4 v19, s[8:11], s59 offen offset:0 lds
    buffer_load_dwordx4 v20, s[8:11], s59 offen offset:1024 lds
    buffer_load_dwordx4 v21, s[8:11], s59 offen offset:2048 lds
    v_xor_b32 v7, v7, v4
    v_lshlrev_b32 v114, 4, v7
    v_lshrrev_b32 v7, 1, v4
    v_lshl_add_u32 v115, v7, 5, v18
    s_lshl3_add_u32 s28, s15, s38
    s_lshl2_add_u32 s28, s28, s33
    s_lshl_b32 s28, s28, 11
    s_add_u32 s63, s28, 262144
    s_lshr_b32 s29, s15, 1
    s_lshl3_add_u32 s29, s29, s38
    s_lshl2_add_u32 s29, s29, s33
    s_lshl_b32 s29, s29, 10
    s_and_b32 s30, s15, 1
    s_lshl_b32 s30, s30, 5
    s_add_u32 s29, s29, s30
    s_add_u32 s64, s29, 2359296
    s_load_dwordx8 s[72:79], s[54:55], 0 glc
    s_load_dwordx8 s[80:87], s[54:55], 2048 glc
    s_lshl_b32 s65, s33, 9
    v_lshrrev_b32 v7, 2, v4
    v_and_b32 v8, 3, v4
    v_lshlrev_b32 v8, 3, v8
    v_lshl_add_u32 v8, v7, 7, v8
    v_bfe_u32 v9, v4, 3, 2
    v_lshl_add_u32 v122, v9, 5, v8
    v_xor_b32 v123, 32, v122
    v_xor_b32 v124, 64, v122
    v_xor_b32 v125, 96, v122
    v_and_b32 v8, 8, v8
    v_lshl_add_u32 v126, v7, 5, v8
    v_lshl_add_u32 v5, v112, 2, v7
    v_mul_u32_u24 v5, 192, v5
    s_mov_b32 s28, 40960
    s_add_u32 m0, s60, 102400
    s_add_u32 s59, s58, 1024
    buffer_load_dwordx4 v19, s[8:11], s59 offen offset:0 lds
    buffer_load_dwordx4 v20, s[8:11], s59 offen offset:1024 lds
    buffer_load_dwordx4 v21, s[8:11], s59 offen offset:2048 lds
    v_add3_u32 v5, v5, v8, s28
    s_mul_i32 s28, s33, 3
    s_add_u32 s29, s28, 2
    v_bfe_u32 v6, v4, 1, 1
    v_lshlrev_b32 v9, 1, v113
    v_add_u32 v7, s28, v6
    v_xor_b32 v7, v7, v9
    v_lshl_add_u32 v72, v7, 4, v5
    v_xor_b32 v73, 16, v72
    v_or_b32 v9, v9, v6
    v_xor_b32 v9, s29, v9
    v_lshl_add_u32 v9, v9, 4, v5
    v_mul_u32_u24 v6, 6144, v6
    v_add_u32 v74, v9, v6
    v_add_u32 v75, 61440, v72
    v_add_u32 v76, 61440, v73
    v_add_u32 v77, 61440, v74
    v_mov_b32 v92, s12
    v_mov_b32 v93, s12
    v_mov_b32 v94, s12
    v_mov_b32 v95, s12
    s_mov_b32 s28, 0xffffd000
    v_cmp_eq_u32 vcc, 31, v24
    v_mad_i32_i24 v32, v22, s28, v19
    v_add_u32 v32, 190464, v32
    v_mad_i32_i24 v33, v23, s28, v20
    v_add_u32 v33, 190464, v33
    v_mad_i32_i24 v34, v24, s28, v21
    v_add_u32 v34, 190464, v34
    v_add_u32 v35, 983040, v34
    v_cndmask_b32 v35, v35, v34, vcc
    s_add_u32 m0, s60, 114688
    s_add_u32 s59, s58, 197632
    buffer_load_dwordx4 v19, s[8:11], s59 offen offset:0 lds
    buffer_load_dwordx4 v20, s[8:11], s59 offen offset:1024 lds
    buffer_load_dwordx4 v21, s[8:11], s59 offen offset:2048 lds
    s_lshl_b32 s28, s39, 6
    v_add_u32 v110, s28, v110
    s_cmp_eq_u32 s45, 0
    s_cselect_b32 s28, 63, 64
    s_cmp_eq_u32 s15, 0
    s_cselect_b32 s28, 8, s28
    s_cselect_b32 s29, 0, -1
    v_and_b32 v6, 0x77, v110
    v_cmp_eq_u32 vcc, s29, v6
    v_xor_b32 v111, s28, v110
    s_mul_i32 s51, s45, 163840
    v_cndmask_b32 v111, v111, v110, vcc
    s_add_u32 s51, s51, 4849664
    v_cmp_le_u32 vcc, 32, v4
    v_lshrrev_b32 v7, 4, v110
    v_mul_u32_u24 v7, 20224, v7
    v_lshl_add_u32 v7, v110, 4, v7
    v_lshl_add_u32 v116, v112, 8, v7
    v_lshl_add_u32 v117, v113, 3, v7
    v_lshrrev_b32 v7, 4, v111
    v_mul_u32_u24 v7, 20224, v7
    v_lshl_add_u32 v7, v111, 4, v7
    v_lshl_add_u32 v118, v112, 8, v7
    v_lshl_add_u32 v119, v113, 3, v7
    v_add_u32 v8, 1024, v111
    v_cndmask_b32 v7, v110, v8, vcc
    v_lshlrev_b32 v7, 3, v7
    v_lshl_add_u32 v120, v113, 2, v7
    s_mul_i32 s28, s38, 1280
    s_add_u32 s56, s51, s28
    s_add_u32 s61, s56, 10240
    s_lshl_b32 s28, s45, 4
    s_add_u32 s28, s28, s38
    s_lshl_b32 s28, s28, 10
    s_add_u32 s62, s28, 7471104
    s_add_u32 m0, s60, 126976
    s_add_u32 s59, s58, 394240
    buffer_load_dwordx4 v19, s[8:11], s59 offen offset:0 lds
    buffer_load_dwordx4 v20, s[8:11], s59 offen offset:1024 lds
    buffer_load_dwordx4 v21, s[8:11], s59 offen offset:2048 lds
    ds_read_b64_tr_b16 a[0:1], v72 offset:0
    ds_read_b64_tr_b16 a[2:3], v72 offset:768
    ds_read_b64_tr_b16 a[4:5], v73 offset:6144
    ds_read_b64_tr_b16 a[6:7], v73 offset:6912
    ds_read_b64_tr_b16 a[8:9], v74 offset:0
    ds_read_b64_tr_b16 a[10:11], v74 offset:768
    ds_read_b64_tr_b16 a[12:13], v72 offset:12288
    ds_read_b64_tr_b16 a[14:15], v72 offset:13056
    ds_read_b64_tr_b16 a[16:17], v73 offset:18432
    ds_read_b64_tr_b16 a[18:19], v73 offset:19200
    ds_read_b64_tr_b16 a[20:21], v74 offset:12288
    ds_read_b64_tr_b16 a[22:23], v74 offset:13056
    s_lshl2_add_u32 m0, s65, 28672
    s_mov_b32 s50, 0
L_p1:
    s_waitcnt lgkmcnt(0)
    s_xor_b64 s[72:73], s[72:73], s[52:53]
    s_xor_b64 s[74:75], s[74:75], s[52:53]
    s_or_b64 s[72:73], s[72:73], s[74:75]
    s_xor_b64 s[76:77], s[76:77], s[52:53]
    s_or_b64 s[72:73], s[72:73], s[76:77]
    s_xor_b64 s[78:79], s[78:79], s[52:53]
    s_or_b64 s[72:73], s[72:73], s[78:79]
    s_xor_b64 s[80:81], s[80:81], s[52:53]
    s_or_b64 s[72:73], s[72:73], s[80:81]
    s_xor_b64 s[82:83], s[82:83], s[52:53]
    s_or_b64 s[72:73], s[72:73], s[82:83]
    s_xor_b64 s[84:85], s[84:85], s[52:53]
    s_or_b64 s[72:73], s[72:73], s[84:85]
    s_xor_b64 s[86:87], s[86:87], s[52:53]
    s_or_b64 s[72:73], s[72:73], s[86:87]
    s_cbranch_scc0 L_p1_done
    s_load_dwordx8 s[72:79], s[54:55], 0 glc
    s_load_dwordx8 s[80:87], s[54:55], 2048 glc
    s_add_u32 s50, s50, 1
    s_cmp_le_u32 s50, 60000
    s_cbranch_scc1 L_p1
    s_waitcnt lgkmcnt(0)
L_p1_done:
    s_waitcnt vmcnt(6)
    s_barrier
    buffer_load_dwordx4 v114, s[24:27], s63 offen sc1 lds
    buffer_load_dwordx4 v114, s[24:27], s63 offen offset:1024 sc1 lds
    s_add_u32 m0, s65, 36864
    s_mov_b32 exec_hi, 0
    buffer_load_dwordx4 v115, s[24:27], s64 offen sc1 lds
    s_mov_b32 exec_hi, -1
    v_lshrrev_b32 v66, 5, v4
    s_add_u32 m0, s60, 139264
    s_add_u32 s59, s58, 590848
    buffer_load_dwordx4 v19, s[8:11], s59 offen offset:0 lds
    buffer_load_dwordx4 v20, s[8:11], s59 offen offset:1024 lds
    buffer_load_dwordx4 v21, s[8:11], s59 offen offset:2048 lds
    v_lshlrev_b32 v66, 11, v66
    v_sub_u32 v66, v70, v66
    v_add_u32 v66, 1024, v66
    v_xor_b32 v66, 32, v66
    v_xor_b32 v67, 0x30, v71
    s_cmp_eq_u32 s49, 0
    s_mov_b32 s31, 0x01000c0c
    s_cselect_b32 s31, s31, 0x03020c0c
    ds_read_b128 v[40:43], v70 offset:0
    ds_read_b128 v[44:47], v70 offset:16
    ds_read_b128 v[48:51], v71 offset:4096
    ds_read_b128 v[52:55], v66 offset:2048
    ds_read_b128 v[56:59], v66 offset:2064
    ds_read_b128 v[60:63], v67 offset:4096
    v_mfma_f32_16x16x32_bf16 v[80:83], a[0:3], v[92:95], 0
    ds_read_b64_tr_b16 a[24:25], v72 offset:24576
    ds_read_b64_tr_b16 a[26:27], v72 offset:25344
    v_mfma_f32_16x16x32_bf16 v[84:87], a[4:7], v[92:95], 0
    ds_read_b64_tr_b16 a[28:29], v73 offset:30720
    ds_read_b64_tr_b16 a[30:31], v73 offset:31488
    v_mfma_f32_16x16x32_bf16 v[88:91], a[8:11], v[92:95], 0
    ds_read_b64_tr_b16 a[32:33], v74 offset:24576
    ds_read_b64_tr_b16 a[34:35], v74 offset:25344
    v_mfma_f32_16x16x32_bf16 v[80:83], a[12:15], v[92:95], v[80:83]
    ds_read_b64_tr_b16 a[36:37], v72 offset:36864
    ds_read_b64_tr_b16 a[38:39], v72 offset:37632
    v_mfma_f32_16x16x32_bf16 v[84:87], a[16:19], v[92:95], v[84:87]
    ds_read_b64_tr_b16 a[40:41], v73 offset:43008
    ds_read_b64_tr_b16 a[42:43], v73 offset:43776
    v_mfma_f32_16x16x32_bf16 v[88:91], a[20:23], v[92:95], v[88:91]
    ds_read_b64_tr_b16 a[44:45], v74 offset:36864
    ds_read_b64_tr_b16 a[46:47], v74 offset:37632
    ds_read_b64_tr_b16 a[48:49], v72 offset:49152
    ds_read_b64_tr_b16 a[50:51], v72 offset:49920
    ds_read_b64_tr_b16 a[52:53], v73 offset:55296
    ds_read_b64_tr_b16 a[54:55], v73 offset:56064
    ds_read_b64_tr_b16 a[56:57], v74 offset:49152
    ds_read_b64_tr_b16 a[58:59], v74 offset:49920
    s_waitcnt lgkmcnt(12)
    v_mfma_f32_16x16x32_bf16 v[80:83], a[24:27], v[92:95], v[80:83]
    ds_read_b64_tr_b16 a[60:61], v75 offset:0
    ds_read_b64_tr_b16 a[62:63], v75 offset:768
    v_mfma_f32_16x16x32_bf16 v[84:87], a[28:31], v[92:95], v[84:87]
    ds_read_b64_tr_b16 a[64:65], v76 offset:6144
    ds_read_b64_tr_b16 a[66:67], v76 offset:6912
    v_mfma_f32_16x16x32_bf16 v[88:91], a[32:35], v[92:95], v[88:91]
    ds_read_b64_tr_b16 a[68:69], v77 offset:0
    ds_read_b64_tr_b16 a[70:71], v77 offset:768
    v_perm_b32 v160, v40, v40, s31
    v_perm_b32 v161, v41, v41, s31
    v_perm_b32 v162, v42, v42, s31
    v_perm_b32 v163, v43, v43, s31
    s_add_u32 m0, s60, 151552
    s_add_u32 s59, s58, 787456
    buffer_load_dwordx4 v19, s[8:11], s59 offen offset:0 lds
    buffer_load_dwordx4 v20, s[8:11], s59 offen offset:1024 lds
    buffer_load_dwordx4 v21, s[8:11], s59 offen offset:2048 lds
    v_perm_b32 v164, v44, v44, s31
    v_perm_b32 v165, v45, v45, s31
    v_perm_b32 v166, v46, v46, s31
    v_perm_b32 v167, v47, v47, s31
    v_perm_b32 v168, v48, v48, s31
    v_perm_b32 v169, v49, v49, s31
    v_perm_b32 v170, v50, v50, s31
    v_perm_b32 v171, v51, v51, s31
    v_perm_b32 v172, v59, v59, s31
    v_perm_b32 v173, v58, v58, s31
    v_perm_b32 v174, v57, v57, s31
    v_perm_b32 v175, v56, v56, s31
    v_perm_b32 v176, v55, v55, s31
    v_perm_b32 v177, v54, v54, s31
    v_perm_b32 v178, v53, v53, s31
    v_perm_b32 v179, v52, v52, s31
    v_perm_b32 v180, v63, v63, s31
    v_perm_b32 v181, v62, v62, s31
    v_perm_b32 v182, v61, v61, s31
    v_perm_b32 v183, v60, v60, s31
    s_add_u32 m0, s60, 40960
    s_add_u32 s59, s58, 1767424
    buffer_load_dwordx4 v32, s[8:11], s59 offen offset:0 lds
    buffer_load_dwordx4 v33, s[8:11], s59 offen offset:1024 lds
    buffer_load_dwordx4 v34, s[8:11], s59 offen offset:2048 lds
    s_cmp_eq_u32 s38, 3
    s_cselect_b32 s28, 1, 2
    v_cmp_eq_u32 vcc, s28, v113
    v_lshlrev_b32 v64, 16, v64
    v_pk_add_f32 v[172:173], v[172:173], v[160:161] neg_lo:[0,1] neg_hi:[0,1]
    v_pk_add_f32 v[174:175], v[174:175], v[162:163] neg_lo:[0,1] neg_hi:[0,1]
    v_pk_add_f32 v[176:177], v[176:177], v[164:165] neg_lo:[0,1] neg_hi:[0,1]
    v_pk_add_f32 v[178:179], v[178:179], v[166:167] neg_lo:[0,1] neg_hi:[0,1]
    v_pk_add_f32 v[180:181], v[180:181], v[168:169] neg_lo:[0,1] neg_hi:[0,1]
    v_pk_add_f32 v[182:183], v[182:183], v[170:171] neg_lo:[0,1] neg_hi:[0,1]
    v_mov_b32 v184, 0
    v_mov_b32 v185, 0
    v_mov_b32 v186, 0
    v_mov_b32 v187, 0
    v_cndmask_b32 v183, v183, v64, vcc
    v_cndmask_b32 v121, 1.0, 0, vcc
    s_lshl2_add_u32 s28, s45, s33
    s_lshl_b32 s28, s28, 11
    s_add_u32 s28, s28, 131072
    s_bfe_u32 s29, s2, 0x40003
    s_cmp_lg_u32 s29, 0
    s_cbranch_scc1 L_nozc
    v_and_b32 v5, 0x3c0, v18
    v_add_u32 v5, v5, v18
    buffer_store_dwordx4 v[184:187], v5, s[24:27], s28 offen sc1
L_nozc:
    s_waitcnt vmcnt(9)
    s_waitcnt lgkmcnt(0)
    s_barrier
    ds_read_b64_tr_b16 v[200:201], v126 offset:36864
    ds_read_b64_tr_b16 v[202:203], v126 offset:37376
    ds_read_b64_tr_b16 v[204:205], v126 offset:37888
    ds_read_b64_tr_b16 v[206:207], v126 offset:38400
    ds_read_b64_tr_b16 v[208:209], v126 offset:36880
    ds_read_b64_tr_b16 v[210:211], v126 offset:37392
    ds_read_b64_tr_b16 v[212:213], v126 offset:37904
    ds_read_b64_tr_b16 v[214:215], v126 offset:38416
    ds_read_b64_tr_b16 v[216:217], v122 offset:28672
    ds_read_b64_tr_b16 v[218:219], v122 offset:30720
    ds_read_b64_tr_b16 v[220:221], v122 offset:32768
    ds_read_b64_tr_b16 v[222:223], v122 offset:34816
    s_waitcnt lgkmcnt(10)
    v_mfma_f32_16x16x32_f16 v[168:171], v[200:203], v[128:131], v[168:171]
    ds_read_b64_tr_b16 v[224:225], v123 offset:28672
    ds_read_b64_tr_b16 v[226:227], v123 offset:30720
    s_waitcnt lgkmcnt(10)
    v_mfma_f32_16x16x32_f16 v[168:171], v[204:207], v[132:135], v[168:171]
    ds_read_b64_tr_b16 v[228:229], v123 offset:32768
    ds_read_b64_tr_b16 v[230:231], v123 offset:34816
    s_waitcnt lgkmcnt(10)
    v_mfma_f32_16x16x32_f16 v[168:171], v[208:211], v[136:139], v[168:171]
    ds_read_b64_tr_b16 v[232:233], v124 offset:28672
    ds_read_b64_tr_b16 v[234:235], v124 offset:30720
    s_waitcnt lgkmcnt(10)
    v_mfma_f32_16x16x32_f16 v[168:171], v[212:215], v[140:143], v[168:171]
    ds_read_b64_tr_b16 v[236:237], v124 offset:32768
    ds_read_b64_tr_b16 v[238:239], v124 offset:34816
    s_waitcnt lgkmcnt(10)
    v_mfma_f32_16x16x32_f16 v[160:163], v[216:219], v[128:131], v[160:163]
    ds_read_b64_tr_b16 v[240:241], v125 offset:28672
    ds_read_b64_tr_b16 v[242:243], v125 offset:30720
    s_waitcnt lgkmcnt(10)
    v_mfma_f32_16x16x32_f16 v[160:163], v[220:223], v[132:135], v[160:163]
    ds_read_b64_tr_b16 v[244:245], v125 offset:32768
    ds_read_b64_tr_b16 v[246:247], v125 offset:34816
    s_waitcnt lgkmcnt(10)
    v_mfma_f32_16x16x32_f16 v[160:163], v[224:227], v[136:139], v[160:163]
    v_add_f32 v180, v180, v168
    v_add_f32 v181, v181, v169
    s_waitcnt lgkmcnt(8)
    v_mfma_f32_16x16x32_f16 v[160:163], v[228:231], v[140:143], v[160:163]
    v_add_f32 v182, v182, v170
    v_fmac_f32 v183, v121, v171
    s_waitcnt lgkmcnt(6)
    v_mfma_f32_16x16x32_f16 v[164:167], v[232:235], v[128:131], v[164:167]
    v_cvt_pk_bf16_f32 v196, v168, v169
    v_cvt_pk_bf16_f32 v198, v180, v181
    s_waitcnt lgkmcnt(4)
    v_mfma_f32_16x16x32_f16 v[164:167], v[236:239], v[132:135], v[164:167]
    v_cvt_pk_bf16_f32 v197, v170, v171
    v_cvt_pk_bf16_f32 v199, v182, v183
    s_waitcnt lgkmcnt(2)
    v_mfma_f32_16x16x32_f16 v[164:167], v[240:243], v[136:139], v[164:167]
    s_waitcnt lgkmcnt(0)
    v_mfma_f32_16x16x32_f16 v[164:167], v[244:247], v[140:143], v[164:167]
    s_mov_b32 exec_hi, 0
    buffer_store_dwordx2 v[196:197], v117, s[24:27], s56 offen offset:1024 sc1
    buffer_store_dwordx2 v[198:199], v119, s[24:27], s61 offen offset:1024 sc1
    v_dot2c_f32_bf16 v184, s12, v196
    v_dot2c_f32_bf16 v185, v196, v196
    v_dot2c_f32_bf16 v186, s12, v198
    v_dot2c_f32_bf16 v187, v198, v198
    v_dot2c_f32_bf16 v184, s12, v197
    v_dot2c_f32_bf16 v185, v197, v197
    v_dot2c_f32_bf16 v186, s12, v199
    v_dot2c_f32_bf16 v187, v199, v199
    s_mov_b32 exec_hi, -1
    v_cvt_pk_bf16_f32 v188, v160, v161
    v_cvt_pk_bf16_f32 v189, v162, v163
    v_cvt_pk_bf16_f32 v190, v164, v165
    v_cvt_pk_bf16_f32 v191, v166, v167
    buffer_store_dwordx4 v[188:191], v116, s[24:27], s56 offen sc1
    v_pk_add_f32 v[172:173], v[172:173], v[160:161]
    v_pk_add_f32 v[174:175], v[174:175], v[162:163]
    v_pk_add_f32 v[176:177], v[176:177], v[164:165]
    v_pk_add_f32 v[178:179], v[178:179], v[166:167]
    v_cvt_pk_bf16_f32 v192, v172, v173
    v_cvt_pk_bf16_f32 v193, v174, v175
    v_cvt_pk_bf16_f32 v194, v176, v177
    v_cvt_pk_bf16_f32 v195, v178, v179
    v_dot2c_f32_bf16 v184, s12, v188
    v_dot2c_f32_bf16 v185, v188, v188
    v_dot2c_f32_bf16 v186, s12, v192
    v_dot2c_f32_bf16 v187, v192, v192
    v_dot2c_f32_bf16 v184, s12, v189
    v_dot2c_f32_bf16 v185, v189, v189
    v_dot2c_f32_bf16 v186, s12, v193
    v_dot2c_f32_bf16 v187, v193, v193
    v_dot2c_f32_bf16 v184, s12, v190
    v_dot2c_f32_bf16 v185, v190, v190
    v_dot2c_f32_bf16 v186, s12, v194
    v_dot2c_f32_bf16 v187, v194, v194
    v_dot2c_f32_bf16 v184, s12, v191
    v_dot2c_f32_bf16 v185, v191, v191
    v_dot2c_f32_bf16 v186, s12, v195
    v_dot2c_f32_bf16 v187, v195, v195
    buffer_store_dwordx4 v[192:195], v118, s[24:27], s61 offen sc1
    s_nop 0
    v_permlane32_swap_b32 v184, v186
    v_permlane32_swap_b32 v185, v187
    v_add_f32 v184, v184, v186
    v_add_f32 v185, v185, v187
    s_nop 1
    v_permlane16_swap_b32 v184, v185
    v_add_f32 v184, v184, v185
    buffer_store_dword v184, v120, s[24:27], s62 offen sc1
    s_lshl2_add_u32 s32, s45, s47
    s_add_u32 m0, s60, 53248
    s_add_u32 s59, s58, 1570816
    buffer_load_dwordx4 v32, s[8:11], s59 offen offset:0 lds
    buffer_load_dwordx4 v33, s[8:11], s59 offen offset:1024 lds
    buffer_load_dwordx4 v34, s[8:11], s59 offen offset:2048 lds
    s_lshl_b32 s32, s32, 9
    s_lshl2_add_u32 s32, s35, s32
    s_add_u32 s32, s32, 65536
    s_lshl_b32 s28, s33, 7
    s_add_u32 s32, s32, s28
    s_mov_b32 s88, s52
    s_add_u32 s92, s24, s32
    s_addc_u32 s93, s25, 0
    s_lshl2_add_u32 s28, s36, s33
    s_lshl2_add_u32 s28, s28, s42
    s_lshl_b32 s28, s28, 7
    s_add_u32 s28, s28, 65536
    s_add_u32 s54, s24, s28
    s_addc_u32 s55, s25, 0
    v_mov_b32 v13, 1
    s_and_b32 s14, s42, 1
    s_and_b32 s13, s42, 2
    s_lshl2_add_u32 s13, s49, s13
    s_add_u32 s13, s13, s39
    s_lshl2_add_u32 s15, s13, s33
    s_mul_i32 s15, s15, 61440
    s_add_u32 s15, s15, 2883584
    s_cmp_eq_u32 s36, 0
    s_cselect_b32 s18, 16, s36
    s_cselect_b64 s[16:17], -1, 0
    s_cmp_eq_u32 s14, 1
    s_cselect_b64 s[56:57], -1, 0
    s_mul_i32 s51, s36, 163840
    s_add_u32 s51, s51, 4849664
    s_lshl_b32 s62, s36, 14
    s_add_u32 s62, s62, 7471104
    s_mul_i32 s34, s33, 5120
    s_add_u32 s19, s51, s34
    v_and_b32 v14, 15, v4
    v_lshlrev_b32 v14, 3, v14
    s_add_u32 m0, s60, 65536
    s_add_u32 s59, s58, 1374208
    buffer_load_dwordx4 v32, s[8:11], s59 offen offset:0 lds
    buffer_load_dwordx4 v33, s[8:11], s59 offen offset:1024 lds
    buffer_load_dwordx4 v34, s[8:11], s59 offen offset:2048 lds
    v_add_u32 v14, 162816, v14
    v_bfe_u32 v5, v4, 4, 1
    v_mul_u32_u24 v5, 49152, v5
    v_and_b32 v6, 15, v4
    v_lshl_add_u32 v5, v6, 4, v5
    v_lshrrev_b32 v6, 5, v4
    v_lshl_add_u32 v15, v6, 8, v5
    v_lshl_add_u32 v17, v6, 3, v5
    s_mul_i32 s30, s36, 393216
    s_add_u32 s30, s30, 7733248
    s_lshl2_add_u32 s28, s37, s33
    s_mul_i32 s28, s28, 768
    s_add_u32 s35, s30, s28
    s_lshl2_add_u32 s28, s14, s33
    s_mul_i32 s28, s28, 12288
    s_add_u32 s46, s30, s28
    s_lshl2_add_u32 s29, s36, s42
    s_lshl2_add_u32 s29, s29, s33
    s_lshl_b32 s29, s29, 9
    s_add_u32 s43, s29, 131072
    s_lshl2_add_u32 s29, s36, s33
    s_lshl2_add_u32 s29, s29, s42
    s_lshl_b32 s29, s29, 9
    s_add_u32 s44, s29, 131072
    s_mul_i32 s45, s33, 24576
    s_add_u32 s45, s45, 61440
    v_add_u32 v25, s45, v18
    v_lshrrev_b32 v5, 4, v4
    v_and_b32 v6, 0xf0, v18
    s_lshl_b32 s29, s33, 8
    s_add_u32 m0, s60, 77824
    s_add_u32 s59, s58, 1177600
    buffer_load_dwordx4 v32, s[8:11], s59 offen offset:0 lds
    buffer_load_dwordx4 v33, s[8:11], s59 offen offset:1024 lds
    buffer_load_dwordx4 v34, s[8:11], s59 offen offset:2048 lds
    v_add_u32 v6, s29, v6
    v_lshl_add_u32 v252, v5, 10, v6
    v_lshrrev_b32 v5, 5, v4
    v_lshl_add_u32 v253, v5, 3, v6
    v_add_u32 v253, 162816, v253
    v_min_u32 v8, 39, v4
    v_mul_u32_u24 v23, 26, v8
    v_lshrrev_b32 v23, 8, v23
    v_mad_i32_i24 v24, v23, -10, v8
    s_lshl_b32 s28, s33, 2
    v_add_u32 v23, s28, v23
    s_mul_i32 s28, s13, 40
    v_lshl_add_u32 v8, v24, 2, s28
    v_sub_u32 v9, 316, v8
    s_cmp_eq_u32 s49, 0
    s_cselect_b64 vcc, -1, 0
    v_cndmask_b32 v9, v9, v8, vcc
    v_lshlrev_b32 v10, 4, v23
    s_mul_i32 s28, s49, 10240
    v_lshrrev_b32 v98, 3, v9
    v_lshl_add_u32 v98, v98, 8, v10
    v_and_b32 v5, 4, v9
    v_lshl_add_u32 v98, v5, 1, v98
    v_add_u32 v98, s28, v98
    v_add_u32 v9, -1, v8
    v_min_u32 v9, 159, v9
    v_lshrrev_b32 v99, 3, v9
    v_lshl_add_u32 v99, v99, 8, v10
    v_mfma_f32_16x16x32_bf16 v[80:83], a[36:39], v[92:95], v[80:83]
    ds_read_b64_tr_b16 a[72:73], v75 offset:12288
    ds_read_b64_tr_b16 a[74:75], v75 offset:13056
    v_mfma_f32_16x16x32_bf16 v[84:87], a[40:43], v[92:95], v[84:87]
    ds_read_b64_tr_b16 a[76:77], v76 offset:18432
    ds_read_b64_tr_b16 a[78:79], v76 offset:19200
    v_mfma_f32_16x16x32_bf16 v[88:91], a[44:47], v[92:95], v[88:91]
    ds_read_b64_tr_b16 a[80:81], v77 offset:12288
    ds_read_b64_tr_b16 a[82:83], v77 offset:13056
    v_mfma_f32_16x16x32_bf16 v[80:83], a[48:51], v[92:95], v[80:83]
    ds_read_b64_tr_b16 a[84:85], v75 offset:24576
    ds_read_b64_tr_b16 a[86:87], v75 offset:25344
    v_mfma_f32_16x16x32_bf16 v[84:87], a[52:55], v[92:95], v[84:87]
    ds_read_b64_tr_b16 a[88:89], v76 offset:30720
    ds_read_b64_tr_b16 a[90:91], v76 offset:31488
    v_mfma_f32_16x16x32_bf16 v[88:91], a[56:59], v[92:95], v[88:91]
    ds_read_b64_tr_b16 a[92:93], v77 offset:24576
    ds_read_b64_tr_b16 a[94:95], v77 offset:25344
    s_waitcnt vmcnt(9)
    s_waitcnt lgkmcnt(0)
    s_barrier
    s_atomic_swap s88, s[92:93], 0 glc
    v_mfma_f32_16x16x32_bf16 v[80:83], a[60:63], v[92:95], v[80:83]
    ds_read_b64_tr_b16 a[96:97], v75 offset:36864
    ds_read_b64_tr_b16 a[98:99], v75 offset:37632
    v_mfma_f32_16x16x32_bf16 v[84:87], a[64:67], v[92:95], v[84:87]
    ds_read_b64_tr_b16 a[100:101], v76 offset:43008
    ds_read_b64_tr_b16 a[102:103], v76 offset:43776
    v_mfma_f32_16x16x32_bf16 v[88:91], a[68:71], v[92:95], v[88:91]
    ds_read_b64_tr_b16 a[104:105], v77 offset:36864
    ds_read_b64_tr_b16 a[106:107], v77 offset:37632
    s_add_u32 m0, s60, 90112
    s_add_u32 s59, s58, 980992
    buffer_load_dwordx4 v32, s[8:11], s59 offen offset:0 lds
    buffer_load_dwordx4 v33, s[8:11], s59 offen offset:1024 lds
    s_add_u32 m0, s60, 92160
    s_nop 0
    buffer_load_dwordx4 v35, s[8:11], s58 offen lds
    v_mfma_f32_16x16x32_bf16 v[80:83], a[72:75], v[92:95], v[80:83]
    ds_read_b64_tr_b16 a[108:109], v75 offset:49152
    ds_read_b64_tr_b16 a[110:111], v75 offset:49920
    v_mfma_f32_16x16x32_bf16 v[84:87], a[76:79], v[92:95], v[84:87]
    ds_read_b64_tr_b16 a[112:113], v76 offset:55296
    ds_read_b64_tr_b16 a[114:115], v76 offset:56064
    v_mfma_f32_16x16x32_bf16 v[88:91], a[80:83], v[92:95], v[88:91]
    ds_read_b64_tr_b16 a[116:117], v77 offset:49152
    ds_read_b64_tr_b16 a[118:119], v77 offset:49920
    v_mfma_f32_16x16x32_bf16 v[80:83], a[84:87], v[92:95], v[80:83]
    ds_read_b64_tr_b16 a[120:121], v72 offset:0
    ds_read_b64_tr_b16 a[122:123], v72 offset:768
    v_mfma_f32_16x16x32_bf16 v[84:87], a[88:91], v[92:95], v[84:87]
    ds_read_b64_tr_b16 a[124:125], v73 offset:6144
    ds_read_b64_tr_b16 a[126:127], v73 offset:6912
    v_mfma_f32_16x16x32_bf16 v[88:91], a[92:95], v[92:95], v[88:91]
    ds_read_b64_tr_b16 a[128:129], v74 offset:0
    ds_read_b64_tr_b16 a[130:131], v74 offset:768
    v_and_b32 v9, 7, v9
    v_lshl_add_u32 v99, v9, 1, v99
    s_add_u32 m0, s60, 102400
    s_add_u32 s59, s58, 1770496
    buffer_load_dwordx4 v32, s[8:11], s59 offen offset:0 lds
    buffer_load_dwordx4 v33, s[8:11], s59 offen offset:1024 lds
    buffer_load_dwordx4 v34, s[8:11], s59 offen offset:2048 lds
    v_cmp_eq_u32 vcc, 0, v8
    v_add_u32 v9, 10240, v99
    v_mov_b32 v22, 0x01000c0c
    v_cndmask_b32 v99, v99, v9, vcc
    v_cmp_ge_u32 vcc, 160, v8
    s_add_u32 m0, s60, 114688
    s_add_u32 s59, s58, 1573888
    buffer_load_dwordx4 v32, s[8:11], s59 offen offset:0 lds
    buffer_load_dwordx4 v33, s[8:11], s59 offen offset:1024 lds
    buffer_load_dwordx4 v34, s[8:11], s59 offen offset:2048 lds
    v_mov_b32 v9, 0x07060c0c
    s_cmp_eq_u32 s49, 0
    s_mov_b32 s28, 0x1000c0c
    s_cselect_b32 s47, s28, 0x7060c0c
    s_mov_b32 s28, 0x3020c0c
    s_cselect_b32 s61, s28, 0x5040c0c
    s_mov_b32 s28, 0x5040c0c
    s_cselect_b32 s64, s28, 0x3020c0c
    s_mov_b32 s28, 0x7060c0c
    s_cselect_b32 s66, s28, 0x1000c0c
    s_mov_b32 s28, 0x1000c0c
    s_cselect_b32 s48, s28, 0x5040c0c
    s_mov_b32 s28, 0x3020c0c
    s_cselect_b32 s63, s28, 0x3020c0c
    s_mov_b32 s28, 0x5040c0c
    s_cselect_b32 s65, s28, 0x1000c0c
    v_cndmask_b32 v22, v9, v22, vcc
    s_mul_i32 s28, s13, 160
    s_mul_i32 s67, s36, 1280
    s_add_u32 m0, s60, 126976
    s_add_u32 s59, s58, 1377280
    buffer_load_dwordx4 v32, s[8:11], s59 offen offset:0 lds
    buffer_load_dwordx4 v33, s[8:11], s59 offen offset:1024 lds
    buffer_load_dwordx4 v34, s[8:11], s59 offen offset:2048 lds
    s_add_u32 s67, s67, s28
    s_sub_u32 s68, 32, s18
    s_mul_i32 s68, s68, 1280
    s_add_u32 s68, s68, s28
    s_mov_b64 exec, 0
    s_cmp_eq_u32 s33, 0
    s_cbranch_scc1 L_pad0
    s_cmp_eq_u32 s33, 1
    s_cbranch_scc1 L_pad1
    s_cmp_eq_u32 s33, 2
    s_cbranch_scc1 L_pad2
    s_branch L_padend
L_padend:
    s_mov_b64 exec, -1
    s_waitcnt vmcnt(9)
    s_waitcnt lgkmcnt(0)
    s_barrier
    s_add_u32 m0, s60, 139264
    s_add_u32 s59, s58, 1180672
    buffer_load_dwordx4 v32, s[8:11], s59 offen offset:0 lds
    buffer_load_dwordx4 v33, s[8:11], s59 offen offset:1024 lds
    buffer_load_dwordx4 v34, s[8:11], s59 offen offset:2048 lds
    s_add_u32 m0, s60, 151552
    s_add_u32 s59, s58, 984064
    buffer_load_dwordx4 v32, s[8:11], s59 offen offset:0 lds
    buffer_load_dwordx4 v33, s[8:11], s59 offen offset:1024 lds
    buffer_load_dwordx4 v34, s[8:11], s59 offen offset:2048 lds
    s_load_dwordx4 s[72:75], s[54:55], 0 glc
    v_mfma_f32_16x16x32_bf16 v[80:83], a[96:99], v[92:95], v[80:83]
    ds_read_b64_tr_b16 a[132:133], v72 offset:12288
    ds_read_b64_tr_b16 a[134:135], v72 offset:13056
    v_mfma_f32_16x16x32_bf16 v[84:87], a[100:103], v[92:95], v[84:87]
    ds_read_b64_tr_b16 a[136:137], v73 offset:18432
    ds_read_b64_tr_b16 a[138:139], v73 offset:19200
    v_mfma_f32_16x16x32_bf16 v[88:91], a[104:107], v[92:95], v[88:91]
    ds_read_b64_tr_b16 a[140:141], v74 offset:12288
    ds_read_b64_tr_b16 a[142:143], v74 offset:13056
    v_mfma_f32_16x16x32_bf16 v[80:83], a[108:111], v[92:95], v[80:83]
    ds_read_b64_tr_b16 a[144:145], v72 offset:24576
    ds_read_b64_tr_b16 a[146:147], v72 offset:25344
    v_mfma_f32_16x16x32_bf16 v[84:87], a[112:115], v[92:95], v[84:87]
    ds_read_b64_tr_b16 a[148:149], v73 offset:30720
    ds_read_b64_tr_b16 a[150:151], v73 offset:31488
    v_mfma_f32_16x16x32_bf16 v[88:91], a[116:119], v[92:95], v[88:91]
    ds_read_b64_tr_b16 a[152:153], v74 offset:24576
    ds_read_b64_tr_b16 a[154:155], v74 offset:25344
    v_mfma_f32_16x16x32_bf16 v[80:83], a[120:123], v[92:95], v[80:83]
    ds_read_b64_tr_b16 a[156:157], v72 offset:36864
    ds_read_b64_tr_b16 a[158:159], v72 offset:37632
    v_mfma_f32_16x16x32_bf16 v[84:87], a[124:127], v[92:95], v[84:87]
    ds_read_b64_tr_b16 a[160:161], v73 offset:43008
    ds_read_b64_tr_b16 a[162:163], v73 offset:43776
    v_mfma_f32_16x16x32_bf16 v[88:91], a[128:131], v[92:95], v[88:91]
    ds_read_b64_tr_b16 a[164:165], v74 offset:36864
    ds_read_b64_tr_b16 a[166:167], v74 offset:37632
    s_waitcnt lgkmcnt(12)
    v_mfma_f32_16x16x32_bf16 v[80:83], a[132:135], v[92:95], v[80:83]
    ds_read_b64_tr_b16 a[168:169], v72 offset:49152
    ds_read_b64_tr_b16 a[170:171], v72 offset:49920
    v_mfma_f32_16x16x32_bf16 v[84:87], a[136:139], v[92:95], v[84:87]
    ds_read_b64_tr_b16 a[172:173], v73 offset:55296
    ds_read_b64_tr_b16 a[174:175], v73 offset:56064
    v_mfma_f32_16x16x32_bf16 v[88:91], a[140:143], v[92:95], v[88:91]
    ds_read_b64_tr_b16 a[176:177], v74 offset:49152
    ds_read_b64_tr_b16 a[178:179], v74 offset:49920
    s_waitcnt lgkmcnt(15)
    v_mfma_f32_16x16x32_bf16 v[80:83], a[144:147], v[92:95], v[80:83]
    s_waitcnt lgkmcnt(14)
    v_mfma_f32_16x16x32_bf16 v[84:87], a[148:151], v[92:95], v[84:87]
    s_waitcnt lgkmcnt(12)
    v_mfma_f32_16x16x32_bf16 v[88:91], a[152:155], v[92:95], v[88:91]
    s_waitcnt lgkmcnt(10)
    v_mfma_f32_16x16x32_bf16 v[80:83], a[156:159], v[92:95], v[80:83]
    s_waitcnt lgkmcnt(8)
    v_mfma_f32_16x16x32_bf16 v[84:87], a[160:163], v[92:95], v[84:87]
    s_waitcnt lgkmcnt(6)
    v_mfma_f32_16x16x32_bf16 v[88:91], a[164:167], v[92:95], v[88:91]
    s_waitcnt lgkmcnt(4)
    v_mfma_f32_16x16x32_bf16 v[80:83], a[168:171], v[92:95], v[80:83]
    s_waitcnt lgkmcnt(2)
    v_mfma_f32_16x16x32_bf16 v[84:87], a[172:175], v[92:95], v[84:87]
    s_waitcnt lgkmcnt(0)
    v_mfma_f32_16x16x32_bf16 v[88:91], a[176:179], v[92:95], v[88:91]
    s_add_u32 m0, s34, 0
    s_add_u32 s4, s19, 0
    s_mov_b32 s50, 0
L_p2:
    s_waitcnt lgkmcnt(0)
    s_xor_b64 s[72:73], s[72:73], s[52:53]
    s_xor_b64 s[74:75], s[74:75], s[52:53]
    s_or_b64 s[72:73], s[72:73], s[74:75]
    s_cbranch_scc0 L_p2_done
    s_load_dwordx4 s[72:75], s[54:55], 0 glc
    s_add_u32 s50, s50, 1
    s_cmp_le_u32 s50, 60000
    s_cbranch_scc1 L_p2
    s_waitcnt lgkmcnt(0)
L_p2_done:
    s_waitcnt vmcnt(3)
    s_barrier
    buffer_load_dwordx4 v18, s[24:27], s4 offen offset:0 sc1 lds
    buffer_load_dwordx4 v18, s[24:27], s4 offen offset:1024 sc1 lds
    buffer_load_dwordx4 v18, s[24:27], s4 offen offset:2048 sc1 lds
    buffer_load_dwordx4 v18, s[24:27], s4 offen offset:3072 sc1 lds
    s_add_u32 m0, s34, 4096
    s_add_u32 s4, s19, 4096
    buffer_load_dwordx4 v18, s[24:27], s4 offen offset:0 sc1 lds
    ds_read_b64_tr_b16 a[180:181], v75 offset:0
    ds_read_b64_tr_b16 a[182:183], v75 offset:768
    ds_read_b64_tr_b16 a[184:185], v76 offset:6144
    ds_read_b64_tr_b16 a[186:187], v76 offset:6912
    ds_read_b64_tr_b16 a[188:189], v77 offset:0
    ds_read_b64_tr_b16 a[190:191], v77 offset:768
    ds_read_b64_tr_b16 a[192:193], v75 offset:12288
    ds_read_b64_tr_b16 a[194:195], v75 offset:13056
    ds_read_b64_tr_b16 a[196:197], v76 offset:18432
    ds_read_b64_tr_b16 a[198:199], v76 offset:19200
    ds_read_b64_tr_b16 a[200:201], v77 offset:12288
    ds_read_b64_tr_b16 a[202:203], v77 offset:13056
    s_add_u32 s4, s62, 0
    buffer_load_dwordx4 v[124:127], v252, s[24:27], s4 offen sc1
    s_add_u32 s4, s62, 4096
    buffer_load_dwordx4 v[128:131], v252, s[24:27], s4 offen sc1
    s_add_u32 s4, s62, 8192
    buffer_load_dwordx4 v[132:135], v252, s[24:27], s4 offen sc1
    s_add_u32 s4, s62, 12288
    buffer_load_dwordx4 v[136:139], v252, s[24:27], s4 offen sc1
    s_waitcnt lgkmcnt(6)
    v_mfma_f32_16x16x32_bf16 v[80:83], a[180:183], v[92:95], v[80:83]
    ds_read_b64_tr_b16 a[204:205], v75 offset:24576
    ds_read_b64_tr_b16 a[206:207], v75 offset:25344
    v_mfma_f32_16x16x32_bf16 v[84:87], a[184:187], v[92:95], v[84:87]
    ds_read_b64_tr_b16 a[208:209], v76 offset:30720
    ds_read_b64_tr_b16 a[210:211], v76 offset:31488
    v_mfma_f32_16x16x32_bf16 v[88:91], a[188:191], v[92:95], v[88:91]
    ds_read_b64_tr_b16 a[212:213], v77 offset:24576
    ds_read_b64_tr_b16 a[214:215], v77 offset:25344
    s_waitcnt lgkmcnt(6)
    v_mfma_f32_16x16x32_bf16 v[80:83], a[192:195], v[92:95], v[80:83]
    ds_read_b64_tr_b16 a[216:217], v75 offset:36864
    ds_read_b64_tr_b16 a[218:219], v75 offset:37632
    v_mfma_f32_16x16x32_bf16 v[84:87], a[196:199], v[92:95], v[84:87]
    ds_read_b64_tr_b16 a[220:221], v76 offset:43008
    ds_read_b64_tr_b16 a[222:223], v76 offset:43776
    v_mfma_f32_16x16x32_bf16 v[88:91], a[200:203], v[92:95], v[88:91]
    ds_read_b64_tr_b16 a[224:225], v77 offset:36864
    ds_read_b64_tr_b16 a[226:227], v77 offset:37632
    s_add_u32 m0, s34, 20480
    s_add_u32 s4, s19, 20480
    buffer_load_dwordx4 v18, s[24:27], s4 offen offset:0 sc1 lds
    buffer_load_dwordx4 v18, s[24:27], s4 offen offset:1024 sc1 lds
    buffer_load_dwordx4 v18, s[24:27], s4 offen offset:2048 sc1 lds
    buffer_load_dwordx4 v18, s[24:27], s4 offen offset:3072 sc1 lds
    s_add_u32 m0, s34, 24576
    s_add_u32 s4, s19, 24576
    buffer_load_dwordx4 v18, s[24:27], s4 offen offset:0 sc1 lds
    s_waitcnt lgkmcnt(10)
    v_mfma_f32_16x16x32_bf16 v[80:83], a[204:207], v[92:95], v[80:83]
    s_waitcnt lgkmcnt(8)
    v_mfma_f32_16x16x32_bf16 v[84:87], a[208:211], v[92:95], v[84:87]
    s_waitcnt lgkmcnt(6)
    v_mfma_f32_16x16x32_bf16 v[88:91], a[212:215], v[92:95], v[88:91]
    s_waitcnt lgkmcnt(4)
    v_mfma_f32_16x16x32_bf16 v[80:83], a[216:219], v[92:95], v[80:83]
    s_waitcnt lgkmcnt(2)
    v_mfma_f32_16x16x32_bf16 v[84:87], a[220:223], v[92:95], v[84:87]
    s_waitcnt lgkmcnt(0)
    v_mfma_f32_16x16x32_bf16 v[88:91], a[224:227], v[92:95], v[88:91]
    s_add_u32 s92, s24, s43
    s_addc_u32 s93, s25, 0
    s_add_u32 s54, s24, s44
    s_addc_u32 s55, s25, 0
    s_mov_b32 s88, 1
    s_mov_b32 s89, 1
    s_mov_b64 s[90:91], s[88:89]
    s_mov_b64 s[72:73], 0
    s_mov_b64 s[74:75], 0
    s_mov_b64 s[76:77], 0
    s_mov_b64 s[78:79], 0
    s_add_u32 s28, s2, s33
    s_cmp_lg_u32 s28, 0
    s_cbranch_scc1 L_noep
    s_mov_b32 s28, 98304
    s_mov_b64 exec, 1
    buffer_store_dword v78, off, s[24:27], s28 sc1
    s_mov_b64 exec, -1
L_noep:
    s_waitcnt vmcnt(9)
    s_barrier
    ds_read_b64_tr_b16 a[228:229], v75 offset:49152
    ds_read_b64_tr_b16 a[230:231], v75 offset:49920
    ds_read_b64_tr_b16 a[232:233], v76 offset:55296
    ds_read_b64_tr_b16 a[234:235], v76 offset:56064
    ds_read_b64_tr_b16 a[236:237], v77 offset:49152
    ds_read_b64_tr_b16 a[238:239], v77 offset:49920
    ds_read_b128 v[56:59], v18 offset:0
    ds_read_b128 v[60:63], v18 offset:1024
    ds_read_b128 v[64:67], v18 offset:2048
    ds_read_b128 v[68:71], v18 offset:3072
    s_waitcnt lgkmcnt(8)
    v_mfma_f32_16x16x32_bf16 v[80:83], a[228:231], v[92:95], v[80:83]
    s_waitcnt lgkmcnt(6)
    v_mfma_f32_16x16x32_bf16 v[84:87], a[232:235], v[92:95], v[84:87]
    s_waitcnt lgkmcnt(4)
    v_mfma_f32_16x16x32_bf16 v[88:91], a[236:239], v[92:95], v[88:91]
    s_waitcnt lgkmcnt(3)
    v_mfma_f32_16x16x32_bf16 v[32:35], a[0:3], v[56:59], 0
    ds_read_b128 v[72:75], v18 offset:4096
    v_lshrrev_b32 v5, 4, v4
    s_waitcnt lgkmcnt(3)
    v_mfma_f32_16x16x32_bf16 v[32:35], a[12:15], v[60:63], v[32:35]
    s_barrier
    ds_read_b128 v[76:79], v18 offset:5120
    v_and_b32 v6, 15, v4
    v_mfma_f32_16x16x32_bf16 v[36:39], a[16:19], v[60:63], 0
    s_add_u32 m0, s34, 40960
    ds_read_b64 v[104:105], v98 offset:5120
    v_mul_u32_u24 v1, 336, v6
    v_mfma_f32_16x16x32_bf16 v[36:39], a[4:7], v[56:59], v[36:39]
    s_add_u32 s4, s19, 40960
    ds_read_b64 v[112:113], v98 offset:0
    v_lshl_add_u32 v1, v5, 3, v1
    v_mfma_f32_16x16x32_bf16 v[40:43], a[8:11], v[56:59], 0
    ds_read_b128 v[56:59], v18 offset:6144
    v_and_b32 v5, 1, v5
    v_mfma_f32_16x16x32_bf16 v[40:43], a[20:23], v[60:63], v[40:43]
    s_waitcnt lgkmcnt(5)
    ds_read_u16 v120, v99 offset:0
    v_mul_u32_u24 v5, 152, v5
    v_mfma_f32_16x16x32_bf16 v[40:43], a[32:35], v[64:67], v[40:43]
    s_waitcnt vmcnt(5)
    v_add_f32 v124, v124, v128
    v_add_f32 v125, v125, v129
    v_mfma_f32_16x16x32_bf16 v[40:43], a[44:47], v[68:71], v[40:43]
    s_mul_i32 s28, s33, 5376
    ds_read_b128 v[60:63], v18 offset:7168
    v_add_f32 v126, v126, v130
    v_mfma_f32_16x16x32_bf16 v[36:39], a[40:43], v[68:71], v[36:39]
    buffer_load_dwordx4 v18, s[24:27], s4 offen offset:0 sc1 lds
    v_add_f32 v127, v127, v131
    v_mfma_f32_16x16x32_bf16 v[36:39], a[28:31], v[64:67], v[36:39]
    v_add_f32 v124, v124, v132
    v_add_f32 v125, v125, v133
    v_mfma_f32_16x16x32_bf16 v[32:35], a[24:27], v[64:67], v[32:35]
    ds_read_b128 v[64:67], v18 offset:8192
    v_add_f32 v126, v126, v134
    v_mfma_f32_16x16x32_bf16 v[32:35], a[36:39], v[68:71], v[32:35]
    s_waitcnt lgkmcnt(6)
    buffer_load_dwordx4 v18, s[24:27], s4 offen offset:1024 sc1 lds
    v_add_f32 v127, v127, v135
    v_mfma_f32_16x16x32_bf16 v[32:35], a[48:51], v[72:75], v[32:35]
    v_add_f32 v124, v124, v136
    v_add_f32 v125, v125, v137
    v_mfma_f32_16x16x32_bf16 v[32:35], a[60:63], v[76:79], v[32:35]
    ds_read_b128 v[68:71], v18 offset:9216
    v_add_f32 v126, v126, v138
    v_mfma_f32_16x16x32_bf16 v[36:39], a[64:67], v[76:79], v[36:39]
    buffer_load_dwordx4 v18, s[24:27], s4 offen offset:2048 sc1 lds
    v_add_f32 v127, v127, v139
    v_mfma_f32_16x16x32_bf16 v[36:39], a[52:55], v[72:75], v[36:39]
    v_mov_b32 v130, 0x3727c5ac
    v_add3_u32 v1, s28, v1, v5
    v_mfma_f32_16x16x32_bf16 v[40:43], a[56:59], v[72:75], v[40:43]
    ds_read_b128 v[72:75], v18 offset:10240
    v_mul_u32_u24 v16, 336, v23
    v_mfma_f32_16x16x32_bf16 v[40:43], a[68:71], v[76:79], v[40:43]
    s_waitcnt lgkmcnt(3)
    buffer_load_dwordx4 v18, s[24:27], s4 offen offset:3072 sc1 lds
    v_lshl_add_u32 v16, v24, 4, v16
    v_mfma_f32_16x16x32_bf16 v[40:43], a[80:83], v[56:59], v[40:43]
    s_lshl_b32 s28, s14, 4
    v_permlane32_swap_b32 v124, v126
    v_mfma_f32_16x16x32_bf16 v[40:43], a[92:95], v[60:63], v[40:43]
    s_add_u32 m0, s34, 45056
    ds_read_b128 v[76:79], v18 offset:11264
    v_add_u32 v23, s28, v23
    v_mfma_f32_16x16x32_bf16 v[36:39], a[88:91], v[60:63], v[36:39]
    v_permlane32_swap_b32 v125, v127
    v_mfma_f32_16x16x32_bf16 v[36:39], a[76:79], v[56:59], v[36:39]
    s_add_u32 s4, s19, 45056
    v_add_f32 v128, v124, v126
    v_add_f32 v124, v124, v126
    v_mfma_f32_16x16x32_bf16 v[32:35], a[72:75], v[56:59], v[32:35]
    ds_read_b128 v[56:59], v18 offset:12288
    v_add_f32 v129, v125, v127
    v_mfma_f32_16x16x32_bf16 v[32:35], a[84:87], v[60:63], v[32:35]
    s_waitcnt lgkmcnt(3)
    v_add_f32 v125, v125, v127
    v_lshlrev_b32 v20, 3, v23
    v_mfma_f32_16x16x32_bf16 v[32:35], a[96:99], v[64:67], v[32:35]
    v_permlane16_swap_b32 v124, v128
    v_mfma_f32_16x16x32_bf16 v[32:35], a[108:111], v[68:71], v[32:35]
    ds_read_b128 v[60:63], v18 offset:13312
    v_add_u32 v20, 162820, v20
    v_mfma_f32_16x16x32_bf16 v[36:39], a[112:115], v[68:71], v[36:39]
    v_permlane16_swap_b32 v125, v129
    v_mfma_f32_16x16x32_bf16 v[36:39], a[100:103], v[64:67], v[36:39]
    buffer_load_dwordx4 v18, s[24:27], s4 offen offset:0 sc1 lds
    v_add_f32 v124, v124, v128
    v_mfma_f32_16x16x32_bf16 v[40:43], a[104:107], v[64:67], v[40:43]
    s_add_u32 m0, s45, 0
    ds_read_b128 v[64:67], v18 offset:14336
    v_add_f32 v125, v125, v129
    v_mfma_f32_16x16x32_bf16 v[40:43], a[116:119], v[68:71], v[40:43]
    s_waitcnt lgkmcnt(3)
    v_mul_f32 v124, 0xbacccccd, v124
    v_fmamk_f32 v125, v125, 0x3acccccd, v130
    v_mfma_f32_16x16x32_bf16 v[40:43], a[128:131], v[72:75], v[40:43]
    v_lshlrev_b32 v24, 4, v24
    v_cmp_le_u32 vcc, 40, v4
    v_mfma_f32_16x16x32_bf16 v[40:43], a[140:143], v[76:79], v[40:43]
    s_add_u32 s4, s15, 24576
    ds_read_b128 v[68:71], v18 offset:15360
    v_fma_f32 v125, -v124, v124, v125
    v_mfma_f32_16x16x32_bf16 v[36:39], a[136:139], v[76:79], v[36:39]
    v_mov_b32 v5, 0x10000000
    v_add_u32 v7, 32, v23
    v_mfma_f32_16x16x32_bf16 v[36:39], a[124:127], v[72:75], v[36:39]
    v_max_f32 v125, v125, v130
    v_cndmask_b32 v24, v24, v5, vcc
    v_mfma_f32_16x16x32_bf16 v[32:35], a[120:123], v[72:75], v[32:35]
    ds_read_b128 v[72:75], v18 offset:16384
    v_lshrrev_b32 v5, 4, v23
    v_mfma_f32_16x16x32_bf16 v[32:35], a[132:135], v[76:79], v[32:35]
    s_waitcnt lgkmcnt(3)
    v_rsq_f32 v125, v125
    v_mfma_f32_16x16x32_bf16 v[32:35], a[144:147], v[56:59], v[32:35]
    buffer_load_dwordx4 v18, s[24:27], s4 offen offset:0 sc1 lds
    v_and_b32 v6, 7, v23
    v_mfma_f32_16x16x32_bf16 v[32:35], a[156:159], v[60:63], v[32:35]
    ds_read_b128 v[76:79], v18 offset:17408
    v_lshl_add_u32 v5, v5, 3, v6
    v_mfma_f32_16x16x32_bf16 v[36:39], a[160:163], v[60:63], v[36:39]
    v_and_b32 v19, 8, v23
    v_cmp_ne_u32 vcc, 0, v19
    v_mfma_f32_16x16x32_bf16 v[36:39], a[148:151], v[56:59], v[36:39]
    buffer_load_dwordx4 v18, s[24:27], s4 offen offset:1024 sc1 lds
    v_mul_f32 v125, 0xbfb8aa3b, v125
    v_mfma_f32_16x16x32_bf16 v[40:43], a[152:155], v[56:59], v[40:43]
    ds_read_b128 v[56:59], v18 offset:18432
    v_sub_u32 v6, 64, v5
    v_mfma_f32_16x16x32_bf16 v[40:43], a[164:167], v[60:63], v[40:43]
    s_waitcnt lgkmcnt(3)
    ds_write_b64 v253, v[124:125]
    v_mfma_f32_16x16x32_bf16 v[40:43], a[176:179], v[64:67], v[40:43]
    ds_read_b128 v[60:63], v18 offset:19456
    v_lshrrev_b32 v19, 6, v6
    v_mfma_f32_16x16x32_bf16 v[40:43], a[188:191], v[68:71], v[40:43]
    buffer_load_dwordx4 v18, s[24:27], s4 offen offset:2048 sc1 lds
    v_lshrrev_b32 v6, v19, v6
    v_mfma_f32_16x16x32_bf16 v[36:39], a[184:187], v[68:71], v[36:39]
    v_cndmask_b32 v5, v5, v6, vcc
    v_cndmask_b32 v19, v23, v5, s[16:17]
    v_mfma_f32_16x16x32_bf16 v[36:39], a[172:175], v[64:67], v[36:39]
    v_mul_u32_u24 v19, 40960, v19
    v_add_u32 v19, v24, v19
    v_mfma_f32_16x16x32_bf16 v[32:35], a[168:171], v[64:67], v[32:35]
    s_waitcnt vmcnt(8)
    buffer_load_dwordx4 v18, s[24:27], s4 offen offset:3072 sc1 lds
    v_lshrrev_b32 v5, 4, v7
    v_mfma_f32_16x16x32_bf16 v[32:35], a[180:183], v[68:71], v[32:35]
    s_waitcnt lgkmcnt(3)
    v_and_b32 v6, 7, v7
    v_lshl_add_u32 v5, v5, 3, v6
    v_mfma_f32_16x16x32_bf16 v[32:35], a[192:195], v[72:75], v[32:35]
    s_waitcnt lgkmcnt(0)
    s_barrier
    v_and_b32 v254, 8, v7
    v_mfma_f32_16x16x32_bf16 v[32:35], a[204:207], v[76:79], v[32:35]
    s_add_u32 m0, s34, 0
    ds_read_b128 v[64:67], v18 offset:20480
    v_cmp_ne_u32 vcc, 0, v254
    v_mfma_f32_16x16x32_bf16 v[36:39], a[208:211], v[76:79], v[36:39]
    s_add_u32 s4, s19, 61440
    v_sub_u32 v6, 64, v5
    v_lshrrev_b32 v254, 6, v6
    v_mfma_f32_16x16x32_bf16 v[36:39], a[196:199], v[72:75], v[36:39]
    ds_read_b128 v[68:71], v18 offset:21504
    v_lshrrev_b32 v6, v254, v6
    v_mfma_f32_16x16x32_bf16 v[40:43], a[200:203], v[72:75], v[40:43]
    ds_read_b128 v[72:75], v18 offset:22528
    v_cndmask_b32 v5, v5, v6, vcc
    v_mfma_f32_16x16x32_bf16 v[40:43], a[212:215], v[76:79], v[40:43]
    v_cndmask_b32 v254, v7, v5, s[16:17]
    v_mul_u32_u24 v254, 40960, v254
    v_mfma_f32_16x16x32_bf16 v[40:43], a[224:227], v[56:59], v[40:43]
    ds_read_b64 v[100:101], v14 offset:0
    v_add_u32 v254, v24, v254
    v_mfma_f32_16x16x32_bf16 v[40:43], a[236:239], v[60:63], v[40:43]
    ds_read_b128 v[76:79], v18 offset:23552
    v_mul_u32_u24 v23, 40960, v23
    v_mfma_f32_16x16x32_bf16 v[36:39], a[232:235], v[60:63], v[36:39]
    buffer_load_dwordx4 v18, s[24:27], s4 offen offset:0 sc1 lds
    v_sub_u32 v23, 1269760, v23
    v_mfma_f32_16x16x32_bf16 v[36:39], a[220:223], v[56:59], v[36:39]
    v_add_u32 v24, v24, v23
    v_mfma_f32_16x16x32_bf16 v[32:35], a[216:219], v[56:59], v[32:35]
    ds_read_b128 v[56:59], v18 offset:24576
    v_mfma_f32_16x16x32_bf16 v[32:35], a[228:231], v[60:63], v[32:35]
    s_waitcnt lgkmcnt(4)
    buffer_load_dwordx4 v18, s[24:27], s4 offen offset:1024 sc1 lds
    v_mfma_f32_16x16x32_bf16 v[44:47], a[0:3], v[64:67], 0
    s_waitcnt lgkmcnt(2)
    v_mfma_f32_16x16x32_bf16 v[44:47], a[12:15], v[68:71], v[44:47]
    ds_read_b128 v[60:63], v18 offset:25600
    v_mfma_f32_16x16x32_bf16 v[48:51], a[16:19], v[68:71], 0
    buffer_load_dwordx4 v18, s[24:27], s4 offen offset:2048 sc1 lds
    v_fmac_f32 v32, v100, v80
    v_mfma_f32_16x16x32_bf16 v[48:51], a[4:7], v[64:67], v[48:51]
    v_fmac_f32 v33, v100, v81
    v_fmac_f32 v36, v100, v84
    v_mfma_f32_16x16x32_bf16 v[52:55], a[8:11], v[64:67], 0
    ds_read_b128 v[64:67], v18 offset:26624
    v_fmac_f32 v40, v100, v88
    v_mfma_f32_16x16x32_bf16 v[52:55], a[20:23], v[68:71], v[52:55]
    s_waitcnt lgkmcnt(3)
    buffer_load_dwordx4 v18, s[24:27], s4 offen offset:3072 sc1 lds
    v_fmac_f32 v42, v100, v90
    v_mfma_f32_16x16x32_bf16 v[52:55], a[32:35], v[72:75], v[52:55]
    s_add_u32 m0, s34, 4096
    v_fmac_f32 v41, v100, v89
    v_fmac_f32 v37, v100, v85
    v_mfma_f32_16x16x32_bf16 v[52:55], a[44:47], v[76:79], v[52:55]
    s_add_u32 s4, s19, 65536
    ds_read_b128 v[68:71], v18 offset:27648
    v_fmac_f32 v43, v100, v91
    v_mfma_f32_16x16x32_bf16 v[48:51], a[40:43], v[76:79], v[48:51]
    v_permlane32_swap_b32 v40, v42
    v_mfma_f32_16x16x32_bf16 v[48:51], a[28:31], v[72:75], v[48:51]
    v_mul_f32 v32, v101, v32
    v_mul_f32 v33, v101, v33
    v_mfma_f32_16x16x32_bf16 v[44:47], a[24:27], v[72:75], v[44:47]
    ds_read_b128 v[72:75], v18 offset:28672
    v_fmac_f32 v34, v100, v82
    v_mfma_f32_16x16x32_bf16 v[44:47], a[36:39], v[76:79], v[44:47]
    s_waitcnt lgkmcnt(3)
    buffer_load_dwordx4 v18, s[24:27], s4 offen offset:0 sc1 lds
    v_fmac_f32 v35, v100, v83
    v_mfma_f32_16x16x32_bf16 v[44:47], a[48:51], v[56:59], v[44:47]
    s_add_u32 m0, s45, 4096
    v_permlane32_swap_b32 v41, v43
    v_mfma_f32_16x16x32_bf16 v[44:47], a[60:63], v[60:63], v[44:47]
    ds_read_b128 v[76:79], v18 offset:29696
    v_mul_f32 v40, v101, v40
    v_mfma_f32_16x16x32_bf16 v[48:51], a[64:67], v[60:63], v[48:51]
    s_add_u32 s4, s15, 28672
    v_exp_f32 v32, v32
    v_mfma_f32_16x16x32_bf16 v[48:51], a[52:55], v[56:59], v[48:51]
    v_fmac_f32 v38, v100, v86
    v_mul_f32 v41, v101, v41
    v_mfma_f32_16x16x32_bf16 v[52:55], a[56:59], v[56:59], v[52:55]
    ds_read_b128 v[56:59], v18 offset:30720
    v_fmac_f32 v39, v100, v87
    v_mfma_f32_16x16x32_bf16 v[52:55], a[68:71], v[60:63], v[52:55]
    s_waitcnt lgkmcnt(3)
    v_exp_f32 v33, v33
    v_mfma_f32_16x16x32_bf16 v[52:55], a[80:83], v[64:67], v[52:55]
    v_exp_f32 v40, v40
    v_mfma_f32_16x16x32_bf16 v[52:55], a[92:95], v[68:71], v[52:55]
    ds_read_b128 v[60:63], v18 offset:31744
    v_mul_f32 v34, v101, v34
    v_mfma_f32_16x16x32_bf16 v[48:51], a[88:91], v[68:71], v[48:51]
    buffer_load_dwordx4 v18, s[24:27], s4 offen offset:0 sc1 lds
    v_mul_f32 v35, v101, v35
    v_mfma_f32_16x16x32_bf16 v[48:51], a[76:79], v[64:67], v[48:51]
    v_add_f32 v32, 1.0, v32
    v_add_f32 v33, 1.0, v33
    v_mfma_f32_16x16x32_bf16 v[44:47], a[72:75], v[64:67], v[44:47]
    ds_read_b128 v[64:67], v18 offset:32768
    v_mfma_f32_16x16x32_bf16 v[44:47], a[84:87], v[68:71], v[44:47]
    s_waitcnt lgkmcnt(3)
    buffer_load_dwordx4 v18, s[24:27], s4 offen offset:1024 sc1 lds
    v_mfma_f32_16x16x32_bf16 v[44:47], a[96:99], v[72:75], v[44:47]
    v_exp_f32 v41, v41
    v_mfma_f32_16x16x32_bf16 v[44:47], a[108:111], v[76:79], v[44:47]
    ds_read_b128 v[68:71], v18 offset:33792
    v_add_f32 v40, 1.0, v40
    v_mfma_f32_16x16x32_bf16 v[48:51], a[112:115], v[76:79], v[48:51]
    buffer_load_dwordx4 v18, s[24:27], s4 offen offset:2048 sc1 lds
    v_add_f32 v41, 1.0, v41
    v_mfma_f32_16x16x32_bf16 v[48:51], a[100:103], v[72:75], v[48:51]
    v_exp_f32 v34, v34
    v_mfma_f32_16x16x32_bf16 v[52:55], a[104:107], v[72:75], v[52:55]
    ds_read_b128 v[72:75], v18 offset:34816
    v_mfma_f32_16x16x32_bf16 v[52:55], a[116:119], v[76:79], v[52:55]
    s_waitcnt lgkmcnt(3)
    buffer_load_dwordx4 v18, s[24:27], s4 offen offset:3072 sc1 lds
    s_add_u32 s4, s15, 0
    v_mfma_f32_16x16x32_bf16 v[52:55], a[128:131], v[56:59], v[52:55]
    s_mov_b64 exec, s[56:57]
    ds_read_b64 v[104:105], v98 offset:25600
    s_mov_b64 exec, -1
    v_mfma_f32_16x16x32_bf16 v[52:55], a[140:143], v[60:63], v[52:55]
    ds_read_b128 v[76:79], v18 offset:35840
    v_mfma_f32_16x16x32_bf16 v[48:51], a[136:139], v[60:63], v[48:51]
    buffer_load_dwordx4 a[240:243], v18, s[24:27], s4 offen offset:0 sc1
    v_mfma_f32_16x16x32_bf16 v[48:51], a[124:127], v[56:59], v[48:51]
    s_mov_b64 exec, s[56:57]
    ds_read_b64 v[112:113], v98 offset:20480
    s_mov_b64 exec, -1
    v_mfma_f32_16x16x32_bf16 v[44:47], a[120:123], v[56:59], v[44:47]
    ds_read_b128 v[56:59], v18 offset:36864
    v_mfma_f32_16x16x32_bf16 v[44:47], a[132:135], v[60:63], v[44:47]
    s_waitcnt lgkmcnt(3)
    buffer_load_dwordx4 a[244:247], v18, s[24:27], s4 offen offset:1024 sc1
    v_mfma_f32_16x16x32_bf16 v[44:47], a[144:147], v[64:67], v[44:47]
    s_mov_b64 exec, s[56:57]
    ds_read_u16 v120, v99 offset:20480
    s_mov_b64 exec, -1
    v_mfma_f32_16x16x32_bf16 v[44:47], a[156:159], v[68:71], v[44:47]
L_pad0:
    s_cbranch_execz L_padend
    ds_read_b128 v[60:63], v18 offset:37888
    v_mfma_f32_16x16x32_bf16 v[48:51], a[160:163], v[68:71], v[48:51]
    buffer_load_dwordx4 a[248:251], v18, s[24:27], s4 offen offset:2048 sc1
    v_mfma_f32_16x16x32_bf16 v[48:51], a[148:151], v[64:67], v[48:51]
    v_exp_f32 v35, v35
    v_mfma_f32_16x16x32_bf16 v[52:55], a[152:155], v[64:67], v[52:55]
    ds_read_b128 v[64:67], v18 offset:38912
    v_add_f32 v34, 1.0, v34
    v_mfma_f32_16x16x32_bf16 v[52:55], a[164:167], v[68:71], v[52:55]
    s_waitcnt lgkmcnt(3)
    buffer_load_dwordx4 a[252:255], v18, s[24:27], s4 offen offset:3072 sc1
    v_add_f32 v35, 1.0, v35
    v_mfma_f32_16x16x32_bf16 v[52:55], a[176:179], v[72:75], v[52:55]
    s_add_u32 s4, s15, 4096
    ds_read_b128 v[68:71], v18 offset:39936
    v_mfma_f32_16x16x32_bf16 v[52:55], a[188:191], v[76:79], v[52:55]
    v_rcp_f32 v32, v32
    v_mfma_f32_16x16x32_bf16 v[48:51], a[184:187], v[76:79], v[48:51]
    v_rcp_f32 v40, v40
    v_mfma_f32_16x16x32_bf16 v[48:51], a[172:175], v[72:75], v[48:51]
    v_rcp_f32 v33, v33
    v_mfma_f32_16x16x32_bf16 v[44:47], a[168:171], v[72:75], v[44:47]
    s_waitcnt vmcnt(17)
    buffer_load_dwordx4 v[172:175], v18, s[24:27], s4 offen offset:0 sc1
    v_mul_f32 v32, v32, v36
    v_mfma_f32_16x16x32_bf16 v[44:47], a[180:183], v[76:79], v[44:47]
    s_waitcnt lgkmcnt(2)
    v_rcp_f32 v34, v34
    v_mfma_f32_16x16x32_bf16 v[44:47], a[192:195], v[56:59], v[44:47]
    s_waitcnt lgkmcnt(0)
    s_barrier
    v_mul_f32 v33, v33, v37
    v_mfma_f32_16x16x32_bf16 v[44:47], a[204:207], v[60:63], v[44:47]
    s_add_u32 m0, s34, 20480
    ds_read_b128 v[72:75], v18 offset:40960
    s_add_u32 s4, s19, 81920
    v_mfma_f32_16x16x32_bf16 v[48:51], a[208:211], v[60:63], v[48:51]
    v_rcp_f32 v41, v41
    v_mfma_f32_16x16x32_bf16 v[48:51], a[196:199], v[56:59], v[48:51]
    ds_read_b128 v[76:79], v18 offset:41984
    v_mul_f32 v40, v40, v42
    v_mfma_f32_16x16x32_bf16 v[52:55], a[200:203], v[56:59], v[52:55]
    ds_read_b128 v[56:59], v18 offset:43008
    v_mul_f32 v41, v41, v43
    v_mfma_f32_16x16x32_bf16 v[52:55], a[212:215], v[60:63], v[52:55]
    v_rcp_f32 v35, v35
    v_mfma_f32_16x16x32_bf16 v[52:55], a[224:227], v[64:67], v[52:55]
    ds_read_b64 v[102:103], v14 offset:128
    v_mul_f32 v34, v34, v38
    v_mfma_f32_16x16x32_bf16 v[52:55], a[236:239], v[68:71], v[52:55]
    ds_read_b128 v[60:63], v18 offset:44032
    v_mul_f32 v35, v35, v39
    v_cvt_pk_bf16_f32 v92, v32, v33
    v_cvt_pk_bf16_f32 v93, v34, v35
    v_cvt_pk_bf16_f32 v96, v40, v41
    v_mfma_f32_16x16x32_bf16 v[48:51], a[232:235], v[68:71], v[48:51]
    buffer_load_dwordx4 v18, s[24:27], s4 offen offset:0 sc1 lds
    v_mfma_f32_16x16x32_bf16 v[48:51], a[220:223], v[64:67], v[48:51]
    v_mfma_f32_16x16x32_bf16 v[44:47], a[216:219], v[64:67], v[44:47]
    ds_read_b128 v[64:67], v18 offset:45056
    v_mfma_f32_16x16x32_bf16 v[44:47], a[228:231], v[68:71], v[44:47]
    s_waitcnt lgkmcnt(4)
    buffer_load_dwordx4 v18, s[24:27], s4 offen offset:1024 sc1 lds
    v_mfma_f32_16x16x32_bf16 v[32:35], a[0:3], v[72:75], 0
    s_waitcnt lgkmcnt(2)
    ds_read_b64 v[106:107], v98 offset:46080
    v_mfma_f32_16x16x32_bf16 v[32:35], a[12:15], v[76:79], v[32:35]
    ds_read_b128 v[68:71], v18 offset:46080
    v_mfma_f32_16x16x32_bf16 v[36:39], a[16:19], v[76:79], 0
    buffer_load_dwordx4 v18, s[24:27], s4 offen offset:2048 sc1 lds
    v_fmac_f32 v44, v102, v80
    v_mfma_f32_16x16x32_bf16 v[36:39], a[4:7], v[72:75], v[36:39]
    ds_read_b64 v[114:115], v98 offset:40960
    v_fmac_f32 v45, v102, v81
    v_mfma_f32_16x16x32_bf16 v[40:43], a[8:11], v[72:75], 0
    ds_read_b128 v[72:75], v18 offset:47104
    v_fmac_f32 v52, v102, v88
    v_mfma_f32_16x16x32_bf16 v[40:43], a[20:23], v[76:79], v[40:43]
    s_waitcnt lgkmcnt(5)
    buffer_load_dwordx4 v18, s[24:27], s4 offen offset:3072 sc1 lds
    v_fmac_f32 v48, v102, v84
    v_mfma_f32_16x16x32_bf16 v[40:43], a[32:35], v[56:59], v[40:43]
    s_add_u32 m0, s34, 24576
    ds_read_u16 v121, v99 offset:40960
    v_fmac_f32 v54, v102, v90
    v_mfma_f32_16x16x32_bf16 v[40:43], a[44:47], v[60:63], v[40:43]
    s_add_u32 s4, s19, 86016
    ds_read_b128 v[76:79], v18 offset:48128
    v_fmac_f32 v53, v102, v89
    v_mfma_f32_16x16x32_bf16 v[36:39], a[40:43], v[60:63], v[36:39]
    v_fmac_f32 v49, v102, v85
    v_fmac_f32 v55, v102, v91
    v_mfma_f32_16x16x32_bf16 v[36:39], a[28:31], v[56:59], v[36:39]
    v_mul_f32 v44, v103, v44
    v_mul_f32 v45, v103, v45
    v_mfma_f32_16x16x32_bf16 v[32:35], a[24:27], v[56:59], v[32:35]
    ds_read_b128 v[56:59], v18 offset:49152
    v_fmac_f32 v46, v102, v82
    v_mfma_f32_16x16x32_bf16 v[32:35], a[36:39], v[60:63], v[32:35]
    s_waitcnt lgkmcnt(5)
    buffer_load_dwordx4 v18, s[24:27], s4 offen offset:0 sc1 lds
    v_fmac_f32 v47, v102, v83
    v_mfma_f32_16x16x32_bf16 v[32:35], a[48:51], v[64:67], v[32:35]
    s_add_u32 m0, s45, 8192
    v_permlane32_swap_b32 v52, v54
    v_mfma_f32_16x16x32_bf16 v[32:35], a[60:63], v[68:71], v[32:35]
    ds_read_b128 v[60:63], v18 offset:50176
    v_fmac_f32 v50, v102, v86
    v_mfma_f32_16x16x32_bf16 v[36:39], a[64:67], v[68:71], v[36:39]
    s_add_u32 s4, s15, 32768
    v_permlane32_swap_b32 v53, v55
    v_mfma_f32_16x16x32_bf16 v[36:39], a[52:55], v[64:67], v[36:39]
    v_exp_f32 v44, v44
    v_mfma_f32_16x16x32_bf16 v[40:43], a[56:59], v[64:67], v[40:43]
    ds_read_b128 v[64:67], v18 offset:51200
    v_mul_f32 v52, v103, v52
    v_mfma_f32_16x16x32_bf16 v[40:43], a[68:71], v[68:71], v[40:43]
    s_waitcnt lgkmcnt(3)
    v_exp_f32 v45, v45
    v_mfma_f32_16x16x32_bf16 v[40:43], a[80:83], v[72:75], v[40:43]
    v_mul_f32 v53, v103, v53
    v_fmac_f32 v51, v102, v87
    v_mfma_f32_16x16x32_bf16 v[40:43], a[92:95], v[76:79], v[40:43]
    ds_read_b128 v[68:71], v18 offset:52224
    v_mul_f32 v46, v103, v46
    v_mfma_f32_16x16x32_bf16 v[36:39], a[88:91], v[76:79], v[36:39]
    buffer_load_dwordx4 v18, s[24:27], s4 offen offset:0 sc1 lds
    v_add_f32 v44, 1.0, v44
    v_mfma_f32_16x16x32_bf16 v[36:39], a[76:79], v[72:75], v[36:39]
    v_exp_f32 v52, v52
    v_mfma_f32_16x16x32_bf16 v[32:35], a[72:75], v[72:75], v[32:35]
    ds_read_b128 v[72:75], v18 offset:53248
    v_mul_f32 v47, v103, v47
    v_mfma_f32_16x16x32_bf16 v[32:35], a[84:87], v[76:79], v[32:35]
    s_waitcnt lgkmcnt(3)
    buffer_load_dwordx4 v18, s[24:27], s4 offen offset:1024 sc1 lds
    v_add_f32 v45, 1.0, v45
    v_mfma_f32_16x16x32_bf16 v[32:35], a[96:99], v[56:59], v[32:35]
    v_exp_f32 v53, v53
    v_mfma_f32_16x16x32_bf16 v[32:35], a[108:111], v[60:63], v[32:35]
    ds_read_b128 v[76:79], v18 offset:54272
    v_add_f32 v52, 1.0, v52
    v_mfma_f32_16x16x32_bf16 v[36:39], a[112:115], v[60:63], v[36:39]
    buffer_load_dwordx4 v18, s[24:27], s4 offen offset:2048 sc1 lds
    v_add_f32 v53, 1.0, v53
    v_mfma_f32_16x16x32_bf16 v[36:39], a[100:103], v[56:59], v[36:39]
    v_exp_f32 v46, v46
    v_mfma_f32_16x16x32_bf16 v[40:43], a[104:107], v[56:59], v[40:43]
    ds_read_b128 v[56:59], v18 offset:55296
    v_mfma_f32_16x16x32_bf16 v[40:43], a[116:119], v[60:63], v[40:43]
    s_waitcnt lgkmcnt(3)
    buffer_load_dwordx4 v18, s[24:27], s4 offen offset:3072 sc1 lds
    s_add_u32 s4, s15, 5120
    v_mfma_f32_16x16x32_bf16 v[40:43], a[128:131], v[64:67], v[40:43]
    v_rcp_f32 v44, v44
    v_mfma_f32_16x16x32_bf16 v[40:43], a[140:143], v[68:71], v[40:43]
    ds_read_b128 v[60:63], v18 offset:56320
    v_mfma_f32_16x16x32_bf16 v[36:39], a[136:139], v[68:71], v[36:39]
    buffer_load_dwordx4 v[176:179], v18, s[24:27], s4 offen offset:0 sc1
    v_mfma_f32_16x16x32_bf16 v[36:39], a[124:127], v[64:67], v[36:39]
    v_exp_f32 v47, v47
    v_mfma_f32_16x16x32_bf16 v[32:35], a[120:123], v[64:67], v[32:35]
    ds_read_b128 v[64:67], v18 offset:57344
    v_add_f32 v46, 1.0, v46
    v_mfma_f32_16x16x32_bf16 v[32:35], a[132:135], v[68:71], v[32:35]
    s_waitcnt lgkmcnt(3)
    buffer_load_dwordx4 v[180:183], v18, s[24:27], s4 offen offset:1024 sc1
    v_add_f32 v47, 1.0, v47
    v_mfma_f32_16x16x32_bf16 v[32:35], a[144:147], v[72:75], v[32:35]
    v_rcp_f32 v45, v45
    v_mfma_f32_16x16x32_bf16 v[32:35], a[156:159], v[76:79], v[32:35]
    ds_read_b128 v[68:71], v18 offset:58368
    v_mul_f32 v44, v44, v48
    v_mfma_f32_16x16x32_bf16 v[36:39], a[160:163], v[76:79], v[36:39]
    buffer_load_dwordx4 v[184:187], v18, s[24:27], s4 offen offset:2048 sc1
    v_mul_f32 v45, v45, v49
    v_mfma_f32_16x16x32_bf16 v[36:39], a[148:151], v[72:75], v[36:39]
    v_rcp_f32 v52, v52
    v_mfma_f32_16x16x32_bf16 v[40:43], a[152:155], v[72:75], v[40:43]
    ds_read_b128 v[72:75], v18 offset:59392
    v_cvt_pk_bf16_f32 v94, v44, v45
    v_mfma_f32_16x16x32_bf16 v[40:43], a[164:167], v[76:79], v[40:43]
    s_waitcnt lgkmcnt(3)
    buffer_load_dwordx4 v[188:191], v18, s[24:27], s4 offen offset:3072 sc1
    s_add_u32 s5, s35, 0
    v_mfma_f32_16x16x32_bf16 v[40:43], a[176:179], v[56:59], v[40:43]
    s_add_u32 s4, s15, 9216
    ds_read_b128 v[76:79], v18 offset:60416
    v_mfma_f32_16x16x32_bf16 v[40:43], a[188:191], v[60:63], v[40:43]
    v_rcp_f32 v46, v46
    v_mfma_f32_16x16x32_bf16 v[36:39], a[184:187], v[60:63], v[36:39]
    v_rcp_f32 v53, v53
    v_mfma_f32_16x16x32_bf16 v[36:39], a[172:175], v[56:59], v[36:39]
    v_rcp_f32 v47, v47
    v_mfma_f32_16x16x32_bf16 v[32:35], a[168:171], v[56:59], v[32:35]
    s_waitcnt vmcnt(22)
    buffer_load_dwordx4 v[192:195], v18, s[24:27], s4 offen offset:0 sc1
    v_mul_f32 v52, v52, v54
    v_mfma_f32_16x16x32_bf16 v[32:35], a[180:183], v[60:63], v[32:35]
    s_waitcnt lgkmcnt(2)
    v_mul_f32 v46, v46, v50
    v_mul_f32 v53, v53, v55
    v_mfma_f32_16x16x32_bf16 v[32:35], a[192:195], v[64:67], v[32:35]
    s_waitcnt lgkmcnt(0)
    s_barrier
    v_mul_f32 v47, v47, v51
    v_mfma_f32_16x16x32_bf16 v[32:35], a[204:207], v[68:71], v[32:35]
    s_add_u32 m0, s34, 40960
    ds_read_b128 v[56:59], v18 offset:0
    v_cvt_pk_bf16_f32 v97, v52, v53
    v_mfma_f32_16x16x32_bf16 v[36:39], a[208:211], v[68:71], v[36:39]
    s_add_u32 s4, s19, 102400
    v_cvt_pk_bf16_f32 v95, v46, v47
    v_mfma_f32_16x16x32_bf16 v[36:39], a[196:199], v[64:67], v[36:39]
    ds_read_b128 v[60:63], v18 offset:1024
    v_mfma_f32_16x16x32_bf16 v[40:43], a[200:203], v[64:67], v[40:43]
    ds_read_b128 v[64:67], v18 offset:2048
    v_mfma_f32_16x16x32_bf16 v[40:43], a[212:215], v[68:71], v[40:43]
    v_permlane16_swap_b32 v92, v94
    v_mfma_f32_16x16x32_bf16 v[40:43], a[224:227], v[72:75], v[40:43]
    ds_read_b64 v[100:101], v14 offset:256
    v_mfma_f32_16x16x32_bf16 v[40:43], a[236:239], v[76:79], v[40:43]
    ds_read_b128 v[68:71], v18 offset:3072
    v_permlane16_swap_b32 v93, v95
    v_permlane16_swap_b32 v96, v97
    v_mfma_f32_16x16x32_bf16 v[36:39], a[232:235], v[76:79], v[36:39]
    buffer_store_dwordx4 v[92:95], v15, s[24:27], s5 offen sc1
    v_mfma_f32_16x16x32_bf16 v[36:39], a[220:223], v[72:75], v[36:39]
    buffer_store_dwordx2 v[96:97], v17, s[24:27], s5 offen offset:512 sc1
    v_mfma_f32_16x16x32_bf16 v[32:35], a[216:219], v[72:75], v[32:35]
    ds_read_b128 v[72:75], v18 offset:4096
    v_mfma_f32_16x16x32_bf16 v[32:35], a[228:231], v[76:79], v[32:35]
    s_waitcnt lgkmcnt(4)
    v_mfma_f32_16x16x32_bf16 v[44:47], a[0:3], v[56:59], 0
    s_waitcnt lgkmcnt(2)
    buffer_load_dwordx4 v18, s[24:27], s4 offen offset:0 sc1 lds
    v_mfma_f32_16x16x32_bf16 v[44:47], a[12:15], v[60:63], v[44:47]
    ds_read_b128 v[76:79], v18 offset:5120
    v_mfma_f32_16x16x32_bf16 v[48:51], a[16:19], v[60:63], 0
    s_nop 0
    v_fmac_f32 v32, v100, v80
    v_fmac_f32 v33, v100, v81
    v_mfma_f32_16x16x32_bf16 v[48:51], a[4:7], v[56:59], v[48:51]
    buffer_load_dwordx4 v18, s[24:27], s4 offen offset:1024 sc1 lds
    v_fmac_f32 v36, v100, v84
    v_mfma_f32_16x16x32_bf16 v[52:55], a[8:11], v[56:59], 0
    ds_read_b128 v[56:59], v18 offset:6144
    v_fmac_f32 v40, v100, v88
    v_mfma_f32_16x16x32_bf16 v[52:55], a[20:23], v[60:63], v[52:55]
    s_waitcnt lgkmcnt(3)
    v_fmac_f32 v42, v100, v90
    v_fmac_f32 v41, v100, v89
    v_mfma_f32_16x16x32_bf16 v[52:55], a[32:35], v[64:67], v[52:55]
    buffer_load_dwordx4 v18, s[24:27], s4 offen offset:2048 sc1 lds
    v_fmac_f32 v37, v100, v85
    v_mfma_f32_16x16x32_bf16 v[52:55], a[44:47], v[68:71], v[52:55]
    ds_read_b128 v[60:63], v18 offset:7168
    v_fmac_f32 v43, v100, v91
    v_mfma_f32_16x16x32_bf16 v[48:51], a[40:43], v[68:71], v[48:51]
    v_permlane32_swap_b32 v40, v42
    v_mfma_f32_16x16x32_bf16 v[48:51], a[28:31], v[64:67], v[48:51]
    buffer_load_dwordx4 v18, s[24:27], s4 offen offset:3072 sc1 lds
    v_mul_f32 v32, v101, v32
    v_mfma_f32_16x16x32_bf16 v[44:47], a[24:27], v[64:67], v[44:47]
    s_add_u32 m0, s34, 45056
    ds_read_b128 v[64:67], v18 offset:8192
    v_mul_f32 v33, v101, v33
    v_mfma_f32_16x16x32_bf16 v[44:47], a[36:39], v[68:71], v[44:47]
    s_waitcnt lgkmcnt(3)
    v_permlane32_swap_b32 v41, v43
    v_mfma_f32_16x16x32_bf16 v[44:47], a[48:51], v[72:75], v[44:47]
    s_add_u32 s4, s19, 106496
    v_exp_f32 v32, v32
    v_mfma_f32_16x16x32_bf16 v[44:47], a[60:63], v[76:79], v[44:47]
    ds_read_b128 v[68:71], v18 offset:9216
    v_fmac_f32 v34, v100, v82
    v_mfma_f32_16x16x32_bf16 v[48:51], a[64:67], v[76:79], v[48:51]
    buffer_load_dwordx4 v18, s[24:27], s4 offen offset:0 sc1 lds
    v_fmac_f32 v35, v100, v83
    v_mfma_f32_16x16x32_bf16 v[48:51], a[52:55], v[72:75], v[48:51]
    s_add_u32 m0, s45, 12288
    v_mul_f32 v40, v101, v40
    v_fmac_f32 v38, v100, v86
    v_mfma_f32_16x16x32_bf16 v[52:55], a[56:59], v[72:75], v[52:55]
    ds_read_b128 v[72:75], v18 offset:10240
    v_mul_f32 v41, v101, v41
    v_mfma_f32_16x16x32_bf16 v[52:55], a[68:71], v[76:79], v[52:55]
    s_waitcnt lgkmcnt(3)
    v_exp_f32 v33, v33
    v_mfma_f32_16x16x32_bf16 v[52:55], a[80:83], v[56:59], v[52:55]
    s_add_u32 s4, s15, 36864
    v_fmac_f32 v39, v100, v87
    v_mul_f32 v34, v101, v34
    v_mfma_f32_16x16x32_bf16 v[52:55], a[92:95], v[60:63], v[52:55]
    ds_read_b128 v[76:79], v18 offset:11264
    v_mul_f32 v35, v101, v35
    v_mfma_f32_16x16x32_bf16 v[48:51], a[88:91], v[60:63], v[48:51]
    v_exp_f32 v40, v40
    v_mfma_f32_16x16x32_bf16 v[48:51], a[76:79], v[56:59], v[48:51]
    v_add_f32 v32, 1.0, v32
    v_add_f32 v33, 1.0, v33
    v_mfma_f32_16x16x32_bf16 v[44:47], a[72:75], v[56:59], v[44:47]
    ds_read_b128 v[56:59], v18 offset:12288
    v_mfma_f32_16x16x32_bf16 v[44:47], a[84:87], v[60:63], v[44:47]
    s_waitcnt lgkmcnt(3)
    buffer_load_dwordx4 v18, s[24:27], s4 offen offset:0 sc1 lds
    v_mfma_f32_16x16x32_bf16 v[44:47], a[96:99], v[64:67], v[44:47]
    v_exp_f32 v41, v41
    v_mfma_f32_16x16x32_bf16 v[44:47], a[108:111], v[68:71], v[44:47]
    ds_read_b128 v[60:63], v18 offset:13312
    v_add_f32 v40, 1.0, v40
    v_mfma_f32_16x16x32_bf16 v[48:51], a[112:115], v[68:71], v[48:51]
    buffer_load_dwordx4 v18, s[24:27], s4 offen offset:1024 sc1 lds
    v_add_f32 v41, 1.0, v41
    v_mfma_f32_16x16x32_bf16 v[48:51], a[100:103], v[64:67], v[48:51]
    v_exp_f32 v34, v34
    v_mfma_f32_16x16x32_bf16 v[52:55], a[104:107], v[64:67], v[52:55]
    ds_read_b128 v[64:67], v18 offset:14336
    v_mfma_f32_16x16x32_bf16 v[52:55], a[116:119], v[68:71], v[52:55]
    s_waitcnt lgkmcnt(3)
    buffer_load_dwordx4 v18, s[24:27], s4 offen offset:2048 sc1 lds
    v_mfma_f32_16x16x32_bf16 v[52:55], a[128:131], v[72:75], v[52:55]
    s_mov_b64 exec, s[56:57]
    ds_read_b64 v[106:107], v98 offset:5120
    s_mov_b64 exec, -1
    v_mfma_f32_16x16x32_bf16 v[52:55], a[140:143], v[76:79], v[52:55]
    ds_read_b128 v[68:71], v18 offset:15360
    v_mfma_f32_16x16x32_bf16 v[48:51], a[136:139], v[76:79], v[48:51]
    buffer_load_dwordx4 v18, s[24:27], s4 offen offset:3072 sc1 lds
    s_add_u32 s4, s15, 10240
    v_mfma_f32_16x16x32_bf16 v[48:51], a[124:127], v[72:75], v[48:51]
    s_mov_b64 exec, s[56:57]
    ds_read_b64 v[114:115], v98 offset:0
    s_mov_b64 exec, -1
    v_mfma_f32_16x16x32_bf16 v[44:47], a[120:123], v[72:75], v[44:47]
    ds_read_b128 v[72:75], v18 offset:16384
    v_mfma_f32_16x16x32_bf16 v[44:47], a[132:135], v[76:79], v[44:47]
    s_waitcnt lgkmcnt(3)
    v_exp_f32 v35, v35
    v_mfma_f32_16x16x32_bf16 v[44:47], a[144:147], v[56:59], v[44:47]
    s_mov_b64 exec, s[56:57]
    ds_read_u16 v121, v99 offset:0
    s_mov_b64 exec, -1
    v_mfma_f32_16x16x32_bf16 v[44:47], a[156:159], v[60:63], v[44:47]
    ds_read_b128 v[76:79], v18 offset:17408
    v_add_f32 v34, 1.0, v34
    v_mfma_f32_16x16x32_bf16 v[48:51], a[160:163], v[60:63], v[48:51]
    buffer_load_dwordx4 v[196:199], v18, s[24:27], s4 offen offset:0 sc1
    v_add_f32 v35, 1.0, v35
    v_mfma_f32_16x16x32_bf16 v[48:51], a[148:151], v[56:59], v[48:51]
    v_rcp_f32 v32, v32
    v_mfma_f32_16x16x32_bf16 v[52:55], a[152:155], v[56:59], v[52:55]
    ds_read_b128 v[56:59], v18 offset:18432
    v_mfma_f32_16x16x32_bf16 v[52:55], a[164:167], v[60:63], v[52:55]
    s_waitcnt lgkmcnt(3)
    buffer_load_dwordx4 v[200:203], v18, s[24:27], s4 offen offset:1024 sc1
    v_mfma_f32_16x16x32_bf16 v[52:55], a[176:179], v[64:67], v[52:55]
    ds_read_b128 v[60:63], v18 offset:19456
    v_mfma_f32_16x16x32_bf16 v[52:55], a[188:191], v[68:71], v[52:55]
    v_rcp_f32 v40, v40
    v_mfma_f32_16x16x32_bf16 v[48:51], a[184:187], v[68:71], v[48:51]
    buffer_load_dwordx4 v[204:207], v18, s[24:27], s4 offen offset:2048 sc1
    v_mfma_f32_16x16x32_bf16 v[48:51], a[172:175], v[64:67], v[48:51]
    v_rcp_f32 v33, v33
    v_mfma_f32_16x16x32_bf16 v[44:47], a[168:171], v[64:67], v[44:47]
    s_waitcnt vmcnt(12)
    v_rcp_f32 v34, v34
    v_mfma_f32_16x16x32_bf16 v[44:47], a[180:183], v[68:71], v[44:47]
    s_waitcnt lgkmcnt(2)
    buffer_load_dwordx4 v[208:211], v18, s[24:27], s4 offen offset:3072 sc1
    v_mul_f32 v32, v32, v36
    v_mfma_f32_16x16x32_bf16 v[44:47], a[192:195], v[72:75], v[44:47]
    s_waitcnt lgkmcnt(0)
    s_barrier
    v_mul_f32 v33, v33, v37
    v_mfma_f32_16x16x32_bf16 v[44:47], a[204:207], v[76:79], v[44:47]
    s_atomic_add s88, s[92:93], 0 glc
    ds_read_b128 v[64:67], v18 offset:20480
    s_add_u32 m0, s34, 0
    v_mfma_f32_16x16x32_bf16 v[48:51], a[208:211], v[76:79], v[48:51]
    s_add_u32 s4, s19, 122880
    v_rcp_f32 v41, v41
    v_mfma_f32_16x16x32_bf16 v[48:51], a[196:199], v[72:75], v[48:51]
    ds_read_b128 v[68:71], v18 offset:21504
    v_mul_f32 v40, v40, v42
    v_mfma_f32_16x16x32_bf16 v[52:55], a[200:203], v[72:75], v[52:55]
    ds_read_b128 v[72:75], v18 offset:22528
    v_mul_f32 v41, v41, v43
    v_mfma_f32_16x16x32_bf16 v[52:55], a[212:215], v[76:79], v[52:55]
    v_rcp_f32 v35, v35
    v_mfma_f32_16x16x32_bf16 v[52:55], a[224:227], v[56:59], v[52:55]
    ds_read_b64 v[102:103], v14 offset:384
    v_mul_f32 v34, v34, v38
    v_mfma_f32_16x16x32_bf16 v[52:55], a[236:239], v[60:63], v[52:55]
    ds_read_b128 v[76:79], v18 offset:23552
    v_mul_f32 v35, v35, v39
    v_cvt_pk_bf16_f32 v92, v32, v33
    v_cvt_pk_bf16_f32 v93, v34, v35
    v_cvt_pk_bf16_f32 v96, v40, v41
    v_mfma_f32_16x16x32_bf16 v[48:51], a[232:235], v[60:63], v[48:51]
    buffer_load_dwordx4 v18, s[24:27], s4 offen offset:0 sc1 lds
    v_mfma_f32_16x16x32_bf16 v[48:51], a[220:223], v[56:59], v[48:51]
    v_mfma_f32_16x16x32_bf16 v[44:47], a[216:219], v[56:59], v[44:47]
    ds_read_b128 v[56:59], v18 offset:24576
    v_mfma_f32_16x16x32_bf16 v[44:47], a[228:231], v[60:63], v[44:47]
    s_waitcnt lgkmcnt(4)
    buffer_load_dwordx4 v18, s[24:27], s4 offen offset:1024 sc1 lds
    v_mfma_f32_16x16x32_bf16 v[32:35], a[0:3], v[64:67], 0
    s_waitcnt lgkmcnt(2)
    ds_read_b64 v[108:109], v98 offset:25600
    v_mfma_f32_16x16x32_bf16 v[32:35], a[12:15], v[68:71], v[32:35]
    ds_read_b128 v[60:63], v18 offset:25600
    v_mfma_f32_16x16x32_bf16 v[36:39], a[16:19], v[68:71], 0
    buffer_load_dwordx4 v18, s[24:27], s4 offen offset:2048 sc1 lds
    v_fmac_f32 v44, v102, v80
    v_mfma_f32_16x16x32_bf16 v[36:39], a[4:7], v[64:67], v[36:39]
    ds_read_b64 v[116:117], v98 offset:20480
    v_fmac_f32 v45, v102, v81
    v_mfma_f32_16x16x32_bf16 v[40:43], a[8:11], v[64:67], 0
    ds_read_b128 v[64:67], v18 offset:26624
    v_fmac_f32 v52, v102, v88
    v_mfma_f32_16x16x32_bf16 v[40:43], a[20:23], v[68:71], v[40:43]
    s_waitcnt lgkmcnt(5)
    buffer_load_dwordx4 v18, s[24:27], s4 offen offset:3072 sc1 lds
    v_fmac_f32 v48, v102, v84
    v_mfma_f32_16x16x32_bf16 v[40:43], a[32:35], v[72:75], v[40:43]
    s_add_u32 m0, s34, 4096
    ds_read_u16 v122, v99 offset:20480
    v_fmac_f32 v54, v102, v90
    v_mfma_f32_16x16x32_bf16 v[40:43], a[44:47], v[76:79], v[40:43]
    ds_read_b128 v[68:71], v18 offset:27648
    v_fmac_f32 v53, v102, v89
    v_mfma_f32_16x16x32_bf16 v[36:39], a[40:43], v[76:79], v[36:39]
    s_add_u32 s4, s19, 126976
    v_fmac_f32 v49, v102, v85
    v_fmac_f32 v55, v102, v91
    v_mfma_f32_16x16x32_bf16 v[36:39], a[28:31], v[72:75], v[36:39]
    v_mul_f32 v44, v103, v44
    v_mul_f32 v45, v103, v45
    v_mfma_f32_16x16x32_bf16 v[32:35], a[24:27], v[72:75], v[32:35]
    ds_read_b128 v[72:75], v18 offset:28672
    v_fmac_f32 v46, v102, v82
    v_mfma_f32_16x16x32_bf16 v[32:35], a[36:39], v[76:79], v[32:35]
    s_waitcnt lgkmcnt(5)
    v_permlane32_swap_b32 v52, v54
    v_mfma_f32_16x16x32_bf16 v[32:35], a[48:51], v[56:59], v[32:35]
    v_permlane32_swap_b32 v53, v55
    v_mfma_f32_16x16x32_bf16 v[32:35], a[60:63], v[60:63], v[32:35]
    ds_read_b128 v[76:79], v18 offset:29696
    v_mul_f32 v52, v103, v52
    v_mfma_f32_16x16x32_bf16 v[36:39], a[64:67], v[60:63], v[36:39]
    buffer_load_dwordx4 v18, s[24:27], s4 offen offset:0 sc1 lds
    v_fmac_f32 v47, v102, v83
    v_mfma_f32_16x16x32_bf16 v[36:39], a[52:55], v[56:59], v[36:39]
    s_add_u32 m0, s45, 16384
    v_exp_f32 v44, v44
    v_mfma_f32_16x16x32_bf16 v[40:43], a[56:59], v[56:59], v[40:43]
    ds_read_b128 v[56:59], v18 offset:30720
    v_fmac_f32 v50, v102, v86
    v_mfma_f32_16x16x32_bf16 v[40:43], a[68:71], v[60:63], v[40:43]
    s_waitcnt lgkmcnt(3)
    v_exp_f32 v45, v45
    v_mfma_f32_16x16x32_bf16 v[40:43], a[80:83], v[64:67], v[40:43]
    s_add_u32 s4, s15, 40960
    v_mul_f32 v53, v103, v53
    v_fmac_f32 v51, v102, v87
    v_mfma_f32_16x16x32_bf16 v[40:43], a[92:95], v[68:71], v[40:43]
    ds_read_b128 v[60:63], v18 offset:31744
    v_mul_f32 v46, v103, v46
    v_mfma_f32_16x16x32_bf16 v[36:39], a[88:91], v[68:71], v[36:39]
    v_exp_f32 v52, v52
    v_mfma_f32_16x16x32_bf16 v[36:39], a[76:79], v[64:67], v[36:39]
    v_add_f32 v44, 1.0, v44
    v_mul_f32 v47, v103, v47
    v_mfma_f32_16x16x32_bf16 v[32:35], a[72:75], v[64:67], v[32:35]
    ds_read_b128 v[64:67], v18 offset:32768
    v_add_f32 v45, 1.0, v45
    v_mfma_f32_16x16x32_bf16 v[32:35], a[84:87], v[68:71], v[32:35]
    s_waitcnt lgkmcnt(3)
    buffer_load_dwordx4 v18, s[24:27], s4 offen offset:0 sc1 lds
    v_mfma_f32_16x16x32_bf16 v[32:35], a[96:99], v[72:75], v[32:35]
    v_exp_f32 v53, v53
    v_mfma_f32_16x16x32_bf16 v[32:35], a[108:111], v[76:79], v[32:35]
    ds_read_b128 v[68:71], v18 offset:33792
    v_add_f32 v52, 1.0, v52
    v_mfma_f32_16x16x32_bf16 v[36:39], a[112:115], v[76:79], v[36:39]
    buffer_load_dwordx4 v18, s[24:27], s4 offen offset:1024 sc1 lds
    v_add_f32 v53, 1.0, v53
    v_mfma_f32_16x16x32_bf16 v[36:39], a[100:103], v[72:75], v[36:39]
    v_exp_f32 v46, v46
    v_mfma_f32_16x16x32_bf16 v[40:43], a[104:107], v[72:75], v[40:43]
    ds_read_b128 v[72:75], v18 offset:34816
    v_mfma_f32_16x16x32_bf16 v[40:43], a[116:119], v[76:79], v[40:43]
    s_waitcnt lgkmcnt(3)
    buffer_load_dwordx4 v18, s[24:27], s4 offen offset:2048 sc1 lds
    v_mfma_f32_16x16x32_bf16 v[40:43], a[128:131], v[56:59], v[40:43]
    v_rcp_f32 v44, v44
    v_mfma_f32_16x16x32_bf16 v[40:43], a[140:143], v[60:63], v[40:43]
    ds_read_b128 v[76:79], v18 offset:35840
    v_mfma_f32_16x16x32_bf16 v[36:39], a[136:139], v[60:63], v[36:39]
    buffer_load_dwordx4 v18, s[24:27], s4 offen offset:3072 sc1 lds
    s_add_u32 s4, s15, 14336
    v_mfma_f32_16x16x32_bf16 v[36:39], a[124:127], v[56:59], v[36:39]
    v_exp_f32 v47, v47
    v_mfma_f32_16x16x32_bf16 v[32:35], a[120:123], v[56:59], v[32:35]
    ds_read_b128 v[56:59], v18 offset:36864
    v_add_f32 v46, 1.0, v46
    v_mfma_f32_16x16x32_bf16 v[32:35], a[132:135], v[60:63], v[32:35]
    s_waitcnt lgkmcnt(3)
    v_rcp_f32 v45, v45
    v_mfma_f32_16x16x32_bf16 v[32:35], a[144:147], v[64:67], v[32:35]
    v_rcp_f32 v52, v52
    v_mfma_f32_16x16x32_bf16 v[32:35], a[156:159], v[68:71], v[32:35]
    ds_read_b128 v[60:63], v18 offset:37888
    v_add_f32 v47, 1.0, v47
    v_mfma_f32_16x16x32_bf16 v[36:39], a[160:163], v[68:71], v[36:39]
    buffer_load_dwordx4 v[212:215], v18, s[24:27], s4 offen offset:0 sc1
    v_mul_f32 v44, v44, v48
    v_mfma_f32_16x16x32_bf16 v[36:39], a[148:151], v[64:67], v[36:39]
    v_rcp_f32 v46, v46
    v_mfma_f32_16x16x32_bf16 v[40:43], a[152:155], v[64:67], v[40:43]
    ds_read_b128 v[64:67], v18 offset:38912
    v_mul_f32 v45, v45, v49
    v_mfma_f32_16x16x32_bf16 v[40:43], a[164:167], v[68:71], v[40:43]
    s_waitcnt lgkmcnt(3)
    buffer_load_dwordx4 v[216:219], v18, s[24:27], s4 offen offset:1024 sc1
    v_cvt_pk_bf16_f32 v94, v44, v45
    v_mfma_f32_16x16x32_bf16 v[40:43], a[176:179], v[72:75], v[40:43]
    s_add_u32 s5, s35, 98304
    ds_read_b128 v[68:71], v18 offset:39936
    v_mfma_f32_16x16x32_bf16 v[40:43], a[188:191], v[76:79], v[40:43]
    v_rcp_f32 v53, v53
    v_mfma_f32_16x16x32_bf16 v[36:39], a[184:187], v[76:79], v[36:39]
    buffer_load_dwordx4 v[220:223], v18, s[24:27], s4 offen offset:2048 sc1
    v_mul_f32 v52, v52, v54
    v_mfma_f32_16x16x32_bf16 v[36:39], a[172:175], v[72:75], v[36:39]
    v_rcp_f32 v47, v47
    v_mfma_f32_16x16x32_bf16 v[32:35], a[168:171], v[72:75], v[32:35]
    s_waitcnt vmcnt(20)
    v_mul_f32 v46, v46, v50
    v_mul_f32 v53, v53, v55
    v_mfma_f32_16x16x32_bf16 v[32:35], a[180:183], v[76:79], v[32:35]
    s_waitcnt lgkmcnt(2)
    buffer_load_dwordx4 v[224:227], v18, s[24:27], s4 offen offset:3072 sc1
    v_mul_f32 v47, v47, v51
    v_mfma_f32_16x16x32_bf16 v[32:35], a[192:195], v[56:59], v[32:35]
    s_waitcnt lgkmcnt(0)
    s_barrier
    v_cvt_pk_bf16_f32 v97, v52, v53
    v_mfma_f32_16x16x32_bf16 v[32:35], a[204:207], v[60:63], v[32:35]
    s_add_u32 m0, s34, 20480
    ds_read_b128 v[72:75], v18 offset:40960
    v_cvt_pk_bf16_f32 v95, v46, v47
    v_mfma_f32_16x16x32_bf16 v[36:39], a[208:211], v[60:63], v[36:39]
    s_add_u32 s4, s19, 143360
    v_permlane16_swap_b32 v92, v94
    v_mfma_f32_16x16x32_bf16 v[36:39], a[196:199], v[56:59], v[36:39]
    ds_read_b128 v[76:79], v18 offset:41984
    v_mfma_f32_16x16x32_bf16 v[40:43], a[200:203], v[56:59], v[40:43]
    ds_read_b128 v[56:59], v18 offset:43008
    v_mfma_f32_16x16x32_bf16 v[40:43], a[212:215], v[60:63], v[40:43]
    v_permlane16_swap_b32 v96, v97
    v_mfma_f32_16x16x32_bf16 v[40:43], a[224:227], v[64:67], v[40:43]
    ds_read_b64 v[100:101], v14 offset:512
    v_mfma_f32_16x16x32_bf16 v[40:43], a[236:239], v[68:71], v[40:43]
    ds_read_b128 v[60:63], v18 offset:44032
    v_permlane16_swap_b32 v93, v95
    v_mfma_f32_16x16x32_bf16 v[36:39], a[232:235], v[68:71], v[36:39]
    buffer_store_dwordx4 v[92:95], v15, s[24:27], s5 offen sc1
    v_mfma_f32_16x16x32_bf16 v[36:39], a[220:223], v[64:67], v[36:39]
    buffer_store_dwordx2 v[96:97], v17, s[24:27], s5 offen offset:512 sc1
    v_mfma_f32_16x16x32_bf16 v[32:35], a[216:219], v[64:67], v[32:35]
    ds_read_b128 v[64:67], v18 offset:45056
    v_mfma_f32_16x16x32_bf16 v[32:35], a[228:231], v[68:71], v[32:35]
    s_waitcnt lgkmcnt(4)
    v_mfma_f32_16x16x32_bf16 v[44:47], a[0:3], v[72:75], 0
    s_waitcnt lgkmcnt(2)
    buffer_load_dwordx4 v18, s[24:27], s4 offen offset:0 sc1 lds
    v_mfma_f32_16x16x32_bf16 v[44:47], a[12:15], v[76:79], v[44:47]
    ds_read_b128 v[68:71], v18 offset:46080
    v_mfma_f32_16x16x32_bf16 v[48:51], a[16:19], v[76:79], 0
    s_nop 0
    v_fmac_f32 v32, v100, v80
    v_fmac_f32 v33, v100, v81
    v_mfma_f32_16x16x32_bf16 v[48:51], a[4:7], v[72:75], v[48:51]
    buffer_load_dwordx4 v18, s[24:27], s4 offen offset:1024 sc1 lds
    v_fmac_f32 v36, v100, v84
    v_mfma_f32_16x16x32_bf16 v[52:55], a[8:11], v[72:75], 0
    ds_read_b128 v[72:75], v18 offset:47104
    v_fmac_f32 v40, v100, v88
    v_mfma_f32_16x16x32_bf16 v[52:55], a[20:23], v[76:79], v[52:55]
    s_waitcnt lgkmcnt(3)
    v_fmac_f32 v42, v100, v90
    v_fmac_f32 v41, v100, v89
    v_mfma_f32_16x16x32_bf16 v[52:55], a[32:35], v[56:59], v[52:55]
    buffer_load_dwordx4 v18, s[24:27], s4 offen offset:2048 sc1 lds
    v_fmac_f32 v37, v100, v85
    v_mfma_f32_16x16x32_bf16 v[52:55], a[44:47], v[60:63], v[52:55]
    ds_read_b128 v[76:79], v18 offset:48128
    v_fmac_f32 v43, v100, v91
    v_mfma_f32_16x16x32_bf16 v[48:51], a[40:43], v[60:63], v[48:51]
    s_atomic_add s72, s[54:55], 0 glc
    v_permlane32_swap_b32 v40, v42
    v_mfma_f32_16x16x32_bf16 v[48:51], a[28:31], v[56:59], v[48:51]
    buffer_load_dwordx4 v18, s[24:27], s4 offen offset:3072 sc1 lds
    v_mul_f32 v32, v101, v32
    v_mfma_f32_16x16x32_bf16 v[44:47], a[24:27], v[56:59], v[44:47]
    s_add_u32 m0, s34, 24576
    ds_read_b128 v[56:59], v18 offset:49152
    v_mul_f32 v33, v101, v33
    v_mfma_f32_16x16x32_bf16 v[44:47], a[36:39], v[60:63], v[44:47]
    s_waitcnt lgkmcnt(3)
    v_permlane32_swap_b32 v41, v43
    v_mfma_f32_16x16x32_bf16 v[44:47], a[48:51], v[64:67], v[44:47]
    s_add_u32 s4, s19, 147456
    v_exp_f32 v32, v32
    v_mfma_f32_16x16x32_bf16 v[44:47], a[60:63], v[68:71], v[44:47]
    ds_read_b128 v[60:63], v18 offset:50176
    v_fmac_f32 v34, v100, v82
    v_mfma_f32_16x16x32_bf16 v[48:51], a[64:67], v[68:71], v[48:51]
    buffer_load_dwordx4 v18, s[24:27], s4 offen offset:0 sc1 lds
    v_fmac_f32 v35, v100, v83
    v_mfma_f32_16x16x32_bf16 v[48:51], a[52:55], v[64:67], v[48:51]
    s_add_u32 m0, s45, 20480
    v_mul_f32 v40, v101, v40
    v_fmac_f32 v38, v100, v86
L_pad1:
    s_cbranch_execz L_padend
    v_mfma_f32_16x16x32_bf16 v[52:55], a[56:59], v[64:67], v[52:55]
    ds_read_b128 v[64:67], v18 offset:51200
    v_mul_f32 v41, v101, v41
    v_mfma_f32_16x16x32_bf16 v[52:55], a[68:71], v[68:71], v[52:55]
    s_waitcnt lgkmcnt(3)
    v_exp_f32 v33, v33
    v_mfma_f32_16x16x32_bf16 v[52:55], a[80:83], v[72:75], v[52:55]
    s_add_u32 s4, s15, 45056
    v_fmac_f32 v39, v100, v87
    v_mul_f32 v34, v101, v34
    v_mfma_f32_16x16x32_bf16 v[52:55], a[92:95], v[76:79], v[52:55]
    ds_read_b128 v[68:71], v18 offset:52224
    v_mul_f32 v35, v101, v35
    v_mfma_f32_16x16x32_bf16 v[48:51], a[88:91], v[76:79], v[48:51]
    v_exp_f32 v40, v40
    v_mfma_f32_16x16x32_bf16 v[48:51], a[76:79], v[72:75], v[48:51]
    v_add_f32 v32, 1.0, v32
    v_add_f32 v33, 1.0, v33
    v_mfma_f32_16x16x32_bf16 v[44:47], a[72:75], v[72:75], v[44:47]
    ds_read_b128 v[72:75], v18 offset:53248
    v_mfma_f32_16x16x32_bf16 v[44:47], a[84:87], v[76:79], v[44:47]
    s_waitcnt lgkmcnt(3)
    buffer_load_dwordx4 v18, s[24:27], s4 offen offset:0 sc1 lds
    v_mfma_f32_16x16x32_bf16 v[44:47], a[96:99], v[56:59], v[44:47]
    v_exp_f32 v41, v41
    v_mfma_f32_16x16x32_bf16 v[44:47], a[108:111], v[60:63], v[44:47]
    ds_read_b128 v[76:79], v18 offset:54272
    v_add_f32 v40, 1.0, v40
    v_mfma_f32_16x16x32_bf16 v[48:51], a[112:115], v[60:63], v[48:51]
    buffer_load_dwordx4 v18, s[24:27], s4 offen offset:1024 sc1 lds
    v_add_f32 v41, 1.0, v41
    v_mfma_f32_16x16x32_bf16 v[48:51], a[100:103], v[56:59], v[48:51]
    v_exp_f32 v34, v34
    v_mfma_f32_16x16x32_bf16 v[52:55], a[104:107], v[56:59], v[52:55]
    ds_read_b128 v[56:59], v18 offset:55296
    v_mfma_f32_16x16x32_bf16 v[52:55], a[116:119], v[60:63], v[52:55]
    s_waitcnt lgkmcnt(3)
    buffer_load_dwordx4 v18, s[24:27], s4 offen offset:2048 sc1 lds
    v_mfma_f32_16x16x32_bf16 v[52:55], a[128:131], v[64:67], v[52:55]
    s_mov_b64 exec, s[56:57]
    ds_read_b64 v[108:109], v98 offset:46080
    s_mov_b64 exec, -1
    v_mfma_f32_16x16x32_bf16 v[52:55], a[140:143], v[68:71], v[52:55]
    ds_read_b128 v[60:63], v18 offset:56320
    v_mfma_f32_16x16x32_bf16 v[48:51], a[136:139], v[68:71], v[48:51]
    buffer_load_dwordx4 v18, s[24:27], s4 offen offset:3072 sc1 lds
    s_add_u32 s4, s15, 18432
    v_mfma_f32_16x16x32_bf16 v[48:51], a[124:127], v[64:67], v[48:51]
    s_mov_b64 exec, s[56:57]
    ds_read_b64 v[116:117], v98 offset:40960
    s_mov_b64 exec, -1
    v_mfma_f32_16x16x32_bf16 v[44:47], a[120:123], v[64:67], v[44:47]
    ds_read_b128 v[64:67], v18 offset:57344
    v_mfma_f32_16x16x32_bf16 v[44:47], a[132:135], v[68:71], v[44:47]
    s_waitcnt lgkmcnt(3)
    v_exp_f32 v35, v35
    v_mfma_f32_16x16x32_bf16 v[44:47], a[144:147], v[72:75], v[44:47]
    s_mov_b64 exec, s[56:57]
    ds_read_u16 v122, v99 offset:40960
    s_mov_b64 exec, -1
    v_mfma_f32_16x16x32_bf16 v[44:47], a[156:159], v[76:79], v[44:47]
    ds_read_b128 v[68:71], v18 offset:58368
    v_add_f32 v34, 1.0, v34
    v_mfma_f32_16x16x32_bf16 v[48:51], a[160:163], v[76:79], v[48:51]
    buffer_load_dwordx4 v[228:231], v18, s[24:27], s4 offen offset:0 sc1
    v_add_f32 v35, 1.0, v35
    v_mfma_f32_16x16x32_bf16 v[48:51], a[148:151], v[72:75], v[48:51]
    v_rcp_f32 v32, v32
    v_mfma_f32_16x16x32_bf16 v[52:55], a[152:155], v[72:75], v[52:55]
    ds_read_b128 v[72:75], v18 offset:59392
    v_mfma_f32_16x16x32_bf16 v[52:55], a[164:167], v[76:79], v[52:55]
    s_waitcnt lgkmcnt(3)
    buffer_load_dwordx4 v[232:235], v18, s[24:27], s4 offen offset:1024 sc1
    v_mfma_f32_16x16x32_bf16 v[52:55], a[176:179], v[56:59], v[52:55]
    ds_read_b128 v[76:79], v18 offset:60416
    v_mfma_f32_16x16x32_bf16 v[52:55], a[188:191], v[60:63], v[52:55]
    v_rcp_f32 v40, v40
    v_mfma_f32_16x16x32_bf16 v[48:51], a[184:187], v[60:63], v[48:51]
    buffer_load_dwordx4 v[236:239], v18, s[24:27], s4 offen offset:2048 sc1
    v_mfma_f32_16x16x32_bf16 v[48:51], a[172:175], v[56:59], v[48:51]
    v_rcp_f32 v33, v33
    v_mfma_f32_16x16x32_bf16 v[44:47], a[168:171], v[56:59], v[44:47]
    s_waitcnt vmcnt(12)
    v_rcp_f32 v34, v34
    v_mfma_f32_16x16x32_bf16 v[44:47], a[180:183], v[60:63], v[44:47]
    s_waitcnt lgkmcnt(2)
    buffer_load_dwordx4 v[240:243], v18, s[24:27], s4 offen offset:3072 sc1
    v_mul_f32 v32, v32, v36
    v_mfma_f32_16x16x32_bf16 v[44:47], a[192:195], v[64:67], v[44:47]
    s_waitcnt lgkmcnt(0)
    s_barrier
    v_mul_f32 v33, v33, v37
    v_mfma_f32_16x16x32_bf16 v[44:47], a[204:207], v[68:71], v[44:47]
    s_add_u32 s4, s15, 22528
    ds_read_b128 v[56:59], v18 offset:0
    s_atomic_add s89, s[92:93], 128 glc
    v_mfma_f32_16x16x32_bf16 v[48:51], a[208:211], v[68:71], v[48:51]
    s_cmp_lt_u32 s72, 4
    s_cbranch_scc1 L_q0
L_q0_ok:
    v_cvt_pk_bf16_f32 v92, v32, v33
    v_mfma_f32_16x16x32_bf16 v[48:51], a[196:199], v[64:67], v[48:51]
    ds_read_b128 v[60:63], v18 offset:1024
    v_mfma_f32_16x16x32_bf16 v[52:55], a[200:203], v[64:67], v[52:55]
    ds_read_b128 v[64:67], v18 offset:2048
    v_mfma_f32_16x16x32_bf16 v[52:55], a[212:215], v[68:71], v[52:55]
    buffer_load_dwordx4 v[244:247], v18, s[24:27], s4 offen offset:0 sc1
    v_mfma_f32_16x16x32_bf16 v[52:55], a[224:227], v[72:75], v[52:55]
    ds_read_b64 v[102:103], v14 offset:640
    v_mfma_f32_16x16x32_bf16 v[52:55], a[236:239], v[76:79], v[52:55]
    ds_read_b128 v[68:71], v18 offset:3072
    v_rcp_f32 v35, v35
    v_mul_f32 v34, v34, v38
    v_mul_f32 v35, v35, v39
    v_cvt_pk_bf16_f32 v93, v34, v35
    v_rcp_f32 v41, v41
    v_mul_f32 v40, v40, v42
    v_mul_f32 v41, v41, v43
    v_cvt_pk_bf16_f32 v96, v40, v41
    v_mfma_f32_16x16x32_bf16 v[48:51], a[232:235], v[76:79], v[48:51]
    buffer_load_dwordx4 v[248:251], v18, s[24:27], s4 offen offset:1024 sc1
    s_add_u32 s4, s46, 0
    v_mfma_f32_16x16x32_bf16 v[48:51], a[220:223], v[72:75], v[48:51]
    v_mfma_f32_16x16x32_bf16 v[44:47], a[216:219], v[72:75], v[44:47]
    ds_read_b128 v[72:75], v18 offset:4096
    v_mfma_f32_16x16x32_bf16 v[44:47], a[228:231], v[76:79], v[44:47]
    s_waitcnt lgkmcnt(4)
    buffer_load_dwordx4 v[124:127], v18, s[24:27], s4 offen offset:0 sc1
    v_mfma_f32_16x16x32_bf16 v[32:35], a[0:3], v[56:59], 0
    s_waitcnt lgkmcnt(2)
    ds_read_b64 v[110:111], v98 offset:5120
    v_mfma_f32_16x16x32_bf16 v[32:35], a[12:15], v[60:63], v[32:35]
    ds_read_b128 v[76:79], v18 offset:5120
    v_mfma_f32_16x16x32_bf16 v[36:39], a[16:19], v[60:63], 0
    buffer_load_dwordx4 v[128:131], v18, s[24:27], s4 offen offset:1024 sc1
    v_fmac_f32 v44, v102, v80
    v_mfma_f32_16x16x32_bf16 v[36:39], a[4:7], v[56:59], v[36:39]
    ds_read_b64 v[118:119], v98 offset:0
    v_fmac_f32 v45, v102, v81
    v_mfma_f32_16x16x32_bf16 v[40:43], a[8:11], v[56:59], 0
    ds_read_b128 v[56:59], v18 offset:6144
    v_fmac_f32 v52, v102, v88
    v_mfma_f32_16x16x32_bf16 v[40:43], a[20:23], v[60:63], v[40:43]
    s_waitcnt lgkmcnt(5)
    buffer_load_dwordx4 v[132:135], v18, s[24:27], s4 offen offset:2048 sc1
    v_fmac_f32 v48, v102, v84
    v_mfma_f32_16x16x32_bf16 v[40:43], a[32:35], v[64:67], v[40:43]
    ds_read_u16 v123, v99 offset:0
    v_fmac_f32 v54, v102, v90
    v_mfma_f32_16x16x32_bf16 v[40:43], a[44:47], v[68:71], v[40:43]
    ds_read_b128 v[60:63], v18 offset:7168
    v_fmac_f32 v53, v102, v89
    v_mfma_f32_16x16x32_bf16 v[36:39], a[40:43], v[68:71], v[36:39]
    v_fmac_f32 v49, v102, v85
    v_fmac_f32 v55, v102, v91
    v_mfma_f32_16x16x32_bf16 v[36:39], a[28:31], v[64:67], v[36:39]
    v_mul_f32 v44, v103, v44
    v_mul_f32 v45, v103, v45
    v_mfma_f32_16x16x32_bf16 v[32:35], a[24:27], v[64:67], v[32:35]
    ds_read_b128 v[64:67], v18 offset:8192
    v_fmac_f32 v46, v102, v82
    v_mfma_f32_16x16x32_bf16 v[32:35], a[36:39], v[68:71], v[32:35]
    s_waitcnt lgkmcnt(5)
    buffer_load_dwordx4 v[136:139], v18, s[24:27], s4 offen offset:3072 sc1
    v_fmac_f32 v47, v102, v83
    v_mfma_f32_16x16x32_bf16 v[32:35], a[48:51], v[72:75], v[32:35]
    v_permlane32_swap_b32 v52, v54
    v_mfma_f32_16x16x32_bf16 v[32:35], a[60:63], v[76:79], v[32:35]
    s_add_u32 s4, s46, 4096
    ds_read_b128 v[68:71], v18 offset:9216
    v_fmac_f32 v50, v102, v86
    v_mfma_f32_16x16x32_bf16 v[36:39], a[64:67], v[76:79], v[36:39]
    v_permlane32_swap_b32 v53, v55
    v_mfma_f32_16x16x32_bf16 v[36:39], a[52:55], v[72:75], v[36:39]
    v_exp_f32 v44, v44
    v_mfma_f32_16x16x32_bf16 v[40:43], a[56:59], v[72:75], v[40:43]
    ds_read_b128 v[72:75], v18 offset:10240
    v_mul_f32 v52, v103, v52
    v_mfma_f32_16x16x32_bf16 v[40:43], a[68:71], v[76:79], v[40:43]
    s_waitcnt lgkmcnt(3)
    v_exp_f32 v45, v45
    v_mfma_f32_16x16x32_bf16 v[40:43], a[80:83], v[56:59], v[40:43]
    v_mul_f32 v53, v103, v53
    v_fmac_f32 v51, v102, v87
    v_mfma_f32_16x16x32_bf16 v[40:43], a[92:95], v[60:63], v[40:43]
    ds_read_b128 v[76:79], v18 offset:11264
    v_mul_f32 v46, v103, v46
    v_mfma_f32_16x16x32_bf16 v[36:39], a[88:91], v[60:63], v[36:39]
    buffer_load_dwordx4 v[140:143], v18, s[24:27], s4 offen offset:0 sc1
    v_add_f32 v44, 1.0, v44
    v_mfma_f32_16x16x32_bf16 v[36:39], a[76:79], v[56:59], v[36:39]
    v_exp_f32 v52, v52
    v_mfma_f32_16x16x32_bf16 v[32:35], a[72:75], v[56:59], v[32:35]
    ds_read_b128 v[56:59], v18 offset:12288
    v_mul_f32 v47, v103, v47
    v_mfma_f32_16x16x32_bf16 v[32:35], a[84:87], v[60:63], v[32:35]
    s_waitcnt lgkmcnt(3)
    v_exp_f32 v53, v53
    v_mfma_f32_16x16x32_bf16 v[32:35], a[96:99], v[64:67], v[32:35]
    buffer_load_dwordx4 v[144:147], v18, s[24:27], s4 offen offset:1024 sc1
    v_add_f32 v45, 1.0, v45
    v_mfma_f32_16x16x32_bf16 v[32:35], a[108:111], v[68:71], v[32:35]
    ds_read_b128 v[60:63], v18 offset:13312
    v_add_f32 v52, 1.0, v52
    v_mfma_f32_16x16x32_bf16 v[36:39], a[112:115], v[68:71], v[36:39]
    v_exp_f32 v46, v46
    v_mfma_f32_16x16x32_bf16 v[36:39], a[100:103], v[64:67], v[36:39]
    v_rcp_f32 v44, v44
    v_mfma_f32_16x16x32_bf16 v[40:43], a[104:107], v[64:67], v[40:43]
    ds_read_b128 v[64:67], v18 offset:14336
    v_add_f32 v53, 1.0, v53
    v_mfma_f32_16x16x32_bf16 v[40:43], a[116:119], v[68:71], v[40:43]
    s_waitcnt lgkmcnt(3)
    buffer_load_dwordx4 v[148:151], v18, s[24:27], s4 offen offset:2048 sc1
    v_mfma_f32_16x16x32_bf16 v[40:43], a[128:131], v[72:75], v[40:43]
    v_exp_f32 v47, v47
    v_mfma_f32_16x16x32_bf16 v[40:43], a[140:143], v[76:79], v[40:43]
    ds_read_b128 v[68:71], v18 offset:15360
    v_add_f32 v46, 1.0, v46
    v_mfma_f32_16x16x32_bf16 v[36:39], a[136:139], v[76:79], v[36:39]
    v_rcp_f32 v45, v45
    v_mfma_f32_16x16x32_bf16 v[36:39], a[124:127], v[72:75], v[36:39]
    buffer_load_dwordx4 v[152:155], v18, s[24:27], s4 offen offset:3072 sc1
    v_add_f32 v47, 1.0, v47
    v_mfma_f32_16x16x32_bf16 v[32:35], a[120:123], v[72:75], v[32:35]
    ds_read_b128 v[72:75], v18 offset:16384
    v_mul_f32 v44, v44, v48
    v_mfma_f32_16x16x32_bf16 v[32:35], a[132:135], v[76:79], v[32:35]
    s_waitcnt lgkmcnt(3)
    v_rcp_f32 v52, v52
    v_mfma_f32_16x16x32_bf16 v[32:35], a[144:147], v[56:59], v[32:35]
    s_add_u32 s4, s46, 8192
    v_rcp_f32 v46, v46
    v_mfma_f32_16x16x32_bf16 v[32:35], a[156:159], v[60:63], v[32:35]
    ds_read_b128 v[76:79], v18 offset:17408
    v_mul_f32 v45, v45, v49
    v_mfma_f32_16x16x32_bf16 v[36:39], a[160:163], v[60:63], v[36:39]
    v_rcp_f32 v53, v53
    v_mfma_f32_16x16x32_bf16 v[36:39], a[148:151], v[56:59], v[36:39]
    v_rcp_f32 v47, v47
    v_mfma_f32_16x16x32_bf16 v[40:43], a[152:155], v[56:59], v[40:43]
    ds_read_b128 v[56:59], v18 offset:18432
    v_mul_f32 v52, v52, v54
    v_mfma_f32_16x16x32_bf16 v[40:43], a[164:167], v[60:63], v[40:43]
    s_waitcnt lgkmcnt(3)
    v_mul_f32 v46, v46, v50
    v_mul_f32 v53, v53, v55
    v_mfma_f32_16x16x32_bf16 v[40:43], a[176:179], v[64:67], v[40:43]
    ds_read_b128 v[60:63], v18 offset:19456
    v_cvt_pk_bf16_f32 v94, v44, v45
    v_mfma_f32_16x16x32_bf16 v[40:43], a[188:191], v[68:71], v[40:43]
    buffer_load_dwordx4 v[156:159], v18, s[24:27], s4 offen offset:0 sc1
    v_mul_f32 v47, v47, v51
    v_mfma_f32_16x16x32_bf16 v[36:39], a[184:187], v[68:71], v[36:39]
    s_add_u32 s5, s35, 196608
    v_cvt_pk_bf16_f32 v97, v52, v53
    v_cvt_pk_bf16_f32 v95, v46, v47
    v_mfma_f32_16x16x32_bf16 v[36:39], a[172:175], v[64:67], v[36:39]
    v_permlane16_swap_b32 v92, v94
    v_mfma_f32_16x16x32_bf16 v[32:35], a[168:171], v[64:67], v[32:35]
    s_waitcnt vmcnt(19)
    v_permlane16_swap_b32 v96, v97
    v_mfma_f32_16x16x32_bf16 v[32:35], a[180:183], v[68:71], v[32:35]
    s_waitcnt lgkmcnt(2)
    buffer_load_dwordx4 v[160:163], v18, s[24:27], s4 offen offset:1024 sc1
    v_mfma_f32_16x16x32_bf16 v[32:35], a[192:195], v[72:75], v[32:35]
    s_waitcnt lgkmcnt(0)
    s_barrier
    v_mfma_f32_16x16x32_bf16 v[32:35], a[204:207], v[76:79], v[32:35]
    ds_read_b128 v[64:67], v18 offset:20480
    v_mfma_f32_16x16x32_bf16 v[36:39], a[208:211], v[76:79], v[36:39]
    v_permlane16_swap_b32 v93, v95
    v_mfma_f32_16x16x32_bf16 v[36:39], a[196:199], v[72:75], v[36:39]
    ds_read_b128 v[68:71], v18 offset:21504
    v_mfma_f32_16x16x32_bf16 v[40:43], a[200:203], v[72:75], v[40:43]
    ds_read_b128 v[72:75], v18 offset:22528
    v_mfma_f32_16x16x32_bf16 v[40:43], a[212:215], v[76:79], v[40:43]
    buffer_store_dwordx4 v[92:95], v15, s[24:27], s5 offen sc1
    v_mfma_f32_16x16x32_bf16 v[40:43], a[224:227], v[56:59], v[40:43]
    ds_read_b64 v[100:101], v14 offset:768
    v_mfma_f32_16x16x32_bf16 v[40:43], a[236:239], v[60:63], v[40:43]
    ds_read_b128 v[76:79], v18 offset:23552
    v_mfma_f32_16x16x32_bf16 v[36:39], a[232:235], v[60:63], v[36:39]
    buffer_store_dwordx2 v[96:97], v17, s[24:27], s5 offen offset:512 sc1
    v_mfma_f32_16x16x32_bf16 v[36:39], a[220:223], v[56:59], v[36:39]
    v_mfma_f32_16x16x32_bf16 v[32:35], a[216:219], v[56:59], v[32:35]
    ds_read_b128 v[56:59], v18 offset:24576
    v_mfma_f32_16x16x32_bf16 v[32:35], a[228:231], v[60:63], v[32:35]
    s_waitcnt lgkmcnt(4)
    buffer_load_dwordx4 v[164:167], v18, s[24:27], s4 offen offset:2048 sc1
    v_mfma_f32_16x16x32_bf16 v[44:47], a[0:3], v[64:67], 0
    s_waitcnt lgkmcnt(2)
    v_mfma_f32_16x16x32_bf16 v[44:47], a[12:15], v[68:71], v[44:47]
    ds_read_b128 v[60:63], v18 offset:25600
    v_mfma_f32_16x16x32_bf16 v[48:51], a[16:19], v[68:71], 0
    buffer_load_dwordx4 v[168:171], v18, s[24:27], s4 offen offset:3072 sc1
    v_fmac_f32 v32, v100, v80
    v_mfma_f32_16x16x32_bf16 v[48:51], a[4:7], v[64:67], v[48:51]
    v_fmac_f32 v33, v100, v81
    v_fmac_f32 v36, v100, v84
    v_mfma_f32_16x16x32_bf16 v[52:55], a[8:11], v[64:67], 0
    s_add_u32 s4, s15, 49152
    ds_read_b128 v[64:67], v18 offset:26624
    v_fmac_f32 v40, v100, v88
    v_mfma_f32_16x16x32_bf16 v[52:55], a[20:23], v[68:71], v[52:55]
    s_waitcnt lgkmcnt(3)
    v_fmac_f32 v42, v100, v90
    v_fmac_f32 v41, v100, v89
    v_mfma_f32_16x16x32_bf16 v[52:55], a[32:35], v[72:75], v[52:55]
    buffer_load_dwordx4 a[0:3], v18, s[24:27], s4 offen offset:0 sc1
    v_fmac_f32 v37, v100, v85
    v_mfma_f32_16x16x32_bf16 v[52:55], a[44:47], v[76:79], v[52:55]
    ds_read_b128 v[68:71], v18 offset:27648
    v_fmac_f32 v43, v100, v91
    v_mfma_f32_16x16x32_bf16 v[48:51], a[40:43], v[76:79], v[48:51]
    v_mov_b32 v11, 0
    v_mul_f32 v32, v101, v32
    v_mfma_f32_16x16x32_bf16 v[48:51], a[28:31], v[72:75], v[48:51]
    s_mov_b64 exec, 1
    buffer_atomic_add v11, off, s[24:27], s44 offset:128 sc0 sc1
    s_mov_b64 exec, -1
    v_mfma_f32_16x16x32_bf16 v[44:47], a[24:27], v[72:75], v[44:47]
    ds_read_b128 v[72:75], v18 offset:28672
    v_mul_f32 v33, v101, v33
    v_mfma_f32_16x16x32_bf16 v[44:47], a[36:39], v[76:79], v[44:47]
    s_waitcnt lgkmcnt(3)
    v_permlane32_swap_b32 v40, v42
    v_mfma_f32_16x16x32_bf16 v[44:47], a[48:51], v[56:59], v[44:47]
    buffer_load_dwordx4 a[4:7], v18, s[24:27], s4 offen offset:1024 sc1
    v_fmac_f32 v34, v100, v82
    v_mfma_f32_16x16x32_bf16 v[44:47], a[60:63], v[60:63], v[44:47]
    ds_read_b128 v[76:79], v18 offset:29696
    v_fmac_f32 v35, v100, v83
    v_mfma_f32_16x16x32_bf16 v[48:51], a[64:67], v[60:63], v[48:51]
    v_permlane32_swap_b32 v41, v43
    v_mfma_f32_16x16x32_bf16 v[48:51], a[52:55], v[56:59], v[48:51]
    buffer_load_dwordx4 a[8:11], v18, s[24:27], s4 offen offset:2048 sc1
    v_mul_f32 v40, v101, v40
    v_mfma_f32_16x16x32_bf16 v[52:55], a[56:59], v[56:59], v[52:55]
    s_waitcnt vmcnt(24)
    ds_read_b128 v[56:59], v18 offset:30720
    v_fmac_f32 v38, v100, v86
    v_mfma_f32_16x16x32_bf16 v[52:55], a[68:71], v[60:63], v[52:55]
    s_waitcnt lgkmcnt(3)
    v_exp_f32 v32, v32
    v_mfma_f32_16x16x32_bf16 v[52:55], a[80:83], v[64:67], v[52:55]
    ds_read_b128 a[48:51], v25 offset:0
    v_mul_f32 v41, v101, v41
    v_mfma_f32_16x16x32_bf16 v[52:55], a[92:95], v[68:71], v[52:55]
    ds_read_b128 v[60:63], v18 offset:31744
    v_fmac_f32 v39, v100, v87
    v_mfma_f32_16x16x32_bf16 v[48:51], a[88:91], v[68:71], v[48:51]
    buffer_load_dwordx4 a[12:15], v18, s[24:27], s4 offen offset:3072 sc1
    v_mul_f32 v34, v101, v34
    v_mfma_f32_16x16x32_bf16 v[48:51], a[76:79], v[64:67], v[48:51]
    s_add_u32 s4, s15, 53248
    ds_read_b128 a[52:55], v25 offset:1024
    v_mul_f32 v35, v101, v35
    v_mfma_f32_16x16x32_bf16 v[44:47], a[72:75], v[64:67], v[44:47]
    ds_read_b128 v[64:67], v18 offset:32768
    v_mfma_f32_16x16x32_bf16 v[44:47], a[84:87], v[68:71], v[44:47]
    s_waitcnt lgkmcnt(5)
    buffer_load_dwordx4 a[16:19], v18, s[24:27], s4 offen offset:0 sc1
    v_mfma_f32_16x16x32_bf16 v[44:47], a[96:99], v[72:75], v[44:47]
    v_exp_f32 v33, v33
    v_mfma_f32_16x16x32_bf16 v[44:47], a[108:111], v[76:79], v[44:47]
    ds_read_b128 v[68:71], v18 offset:33792
    v_add_f32 v32, 1.0, v32
    v_mfma_f32_16x16x32_bf16 v[48:51], a[112:115], v[76:79], v[48:51]
    ds_read_b128 a[56:59], v25 offset:2048
    v_add_f32 v33, 1.0, v33
    v_mfma_f32_16x16x32_bf16 v[48:51], a[100:103], v[72:75], v[48:51]
    v_exp_f32 v40, v40
    v_mfma_f32_16x16x32_bf16 v[52:55], a[104:107], v[72:75], v[52:55]
    ds_read_b128 v[72:75], v18 offset:34816
    v_mfma_f32_16x16x32_bf16 v[52:55], a[116:119], v[76:79], v[52:55]
    s_waitcnt lgkmcnt(5)
    buffer_load_dwordx4 a[20:23], v18, s[24:27], s4 offen offset:1024 sc1
    v_mfma_f32_16x16x32_bf16 v[52:55], a[128:131], v[56:59], v[52:55]
    v_exp_f32 v41, v41
    v_mfma_f32_16x16x32_bf16 v[52:55], a[140:143], v[60:63], v[52:55]
    ds_read_b128 v[76:79], v18 offset:35840
    v_add_f32 v40, 1.0, v40
    v_mfma_f32_16x16x32_bf16 v[48:51], a[136:139], v[60:63], v[48:51]
    buffer_load_dwordx4 a[24:27], v18, s[24:27], s4 offen offset:2048 sc1
    v_add_f32 v41, 1.0, v41
    v_mfma_f32_16x16x32_bf16 v[48:51], a[124:127], v[56:59], v[48:51]
    v_exp_f32 v34, v34
    v_mfma_f32_16x16x32_bf16 v[44:47], a[120:123], v[56:59], v[44:47]
    ds_read_b128 v[56:59], v18 offset:36864
    v_mfma_f32_16x16x32_bf16 v[44:47], a[132:135], v[60:63], v[44:47]
    s_waitcnt lgkmcnt(4)
    buffer_load_dwordx4 a[28:31], v18, s[24:27], s4 offen offset:3072 sc1
    s_add_u32 s4, s15, 57344
    v_mfma_f32_16x16x32_bf16 v[44:47], a[144:147], v[64:67], v[44:47]
    v_exp_f32 v35, v35
    v_mfma_f32_16x16x32_bf16 v[44:47], a[156:159], v[68:71], v[44:47]
    ds_read_b128 v[60:63], v18 offset:37888
    v_add_f32 v34, 1.0, v34
    v_mfma_f32_16x16x32_bf16 v[48:51], a[160:163], v[68:71], v[48:51]
    ds_read_b128 a[60:63], v25 offset:3072
    v_add_f32 v35, 1.0, v35
    v_mfma_f32_16x16x32_bf16 v[48:51], a[148:151], v[64:67], v[48:51]
    buffer_load_dwordx4 a[32:35], v18, s[24:27], s4 offen offset:0 sc1
    v_mfma_f32_16x16x32_bf16 v[52:55], a[152:155], v[64:67], v[52:55]
    ds_read_b128 v[64:67], v18 offset:38912
    v_mfma_f32_16x16x32_bf16 v[52:55], a[164:167], v[68:71], v[52:55]
    s_waitcnt lgkmcnt(4)
    v_rcp_f32 v32, v32
    v_mfma_f32_16x16x32_bf16 v[52:55], a[176:179], v[72:75], v[52:55]
    buffer_load_dwordx4 a[36:39], v18, s[24:27], s4 offen offset:1024 sc1
    v_mfma_f32_16x16x32_bf16 v[52:55], a[188:191], v[76:79], v[52:55]
    ds_read_b128 v[68:71], v18 offset:39936
    v_mfma_f32_16x16x32_bf16 v[48:51], a[184:187], v[76:79], v[48:51]
    v_rcp_f32 v40, v40
    v_mfma_f32_16x16x32_bf16 v[48:51], a[172:175], v[72:75], v[48:51]
    s_waitcnt vmcnt(13)
    s_barrier
    buffer_load_dwordx4 a[40:43], v18, s[24:27], s4 offen offset:2048 sc1
    v_mfma_f32_16x16x32_bf16 v[44:47], a[168:171], v[72:75], v[44:47]
    s_atomic_add s90, s[92:93], 256 glc
    v_rcp_f32 v33, v33
    v_mfma_f32_16x16x32_bf16 v[44:47], a[180:183], v[76:79], v[44:47]
    s_waitcnt lgkmcnt(3)
    ds_read_b128 a[64:67], v25 offset:4096
    v_mul_f32 v32, v32, v36
    v_mfma_f32_16x16x32_bf16 v[44:47], a[192:195], v[56:59], v[44:47]
    buffer_load_dwordx4 a[44:47], v18, s[24:27], s4 offen offset:3072 sc1
    v_mul_f32 v33, v33, v37
    v_mfma_f32_16x16x32_bf16 v[44:47], a[204:207], v[60:63], v[44:47]
    ds_read_b128 a[68:71], v25 offset:5120
    v_cvt_pk_bf16_f32 v92, v32, v33
    v_mfma_f32_16x16x32_bf16 v[48:51], a[208:211], v[60:63], v[48:51]
    ds_read_b128 a[72:75], v25 offset:6144
    v_mfma_f32_16x16x32_bf16 v[48:51], a[196:199], v[56:59], v[48:51]
    ds_read_b128 a[76:79], v25 offset:7168
    v_mfma_f32_16x16x32_bf16 v[52:55], a[200:203], v[56:59], v[52:55]
    ds_read_b128 a[80:83], v25 offset:8192
    v_mfma_f32_16x16x32_bf16 v[52:55], a[212:215], v[60:63], v[52:55]
    s_waitcnt lgkmcnt(5)
    ds_read_b128 a[84:87], v25 offset:9216
    s_waitcnt vmcnt(11)
    v_readfirstlane_b32 s6, v11
    s_cmp_lt_u32 s6, 4
    s_cbranch_scc1 L_q1
L_q1_ok:
    v_mfma_f32_16x16x32_bf16 v[52:55], a[224:227], v[64:67], v[52:55]
    s_add_u32 s4, s46, 98304
    ds_read_b64 v[102:103], v14 offset:896
    v_mfma_f32_16x16x32_bf16 v[52:55], a[236:239], v[68:71], v[52:55]
    buffer_load_dwordx4 a[144:147], v18, s[24:27], s4 offen offset:0 sc1
    v_rcp_f32 v34, v34
    v_rcp_f32 v35, v35
    v_mul_f32 v34, v34, v38
    v_mul_f32 v35, v35, v39
    v_cvt_pk_bf16_f32 v93, v34, v35
    v_rcp_f32 v41, v41
    v_mul_f32 v40, v40, v42
    v_mul_f32 v41, v41, v43
    v_cvt_pk_bf16_f32 v96, v40, v41
    v_mfma_f32_16x16x32_bf16 v[48:51], a[232:235], v[68:71], v[48:51]
    ds_read_b128 a[88:91], v25 offset:10240
    v_mfma_f32_16x16x32_bf16 v[48:51], a[220:223], v[64:67], v[48:51]
    ds_read_b128 a[92:95], v25 offset:11264
    v_mfma_f32_16x16x32_bf16 v[44:47], a[216:219], v[64:67], v[44:47]
    ds_read_b128 a[96:99], v25 offset:12288
    v_mfma_f32_16x16x32_bf16 v[44:47], a[228:231], v[68:71], v[44:47]
    buffer_load_dwordx4 a[148:151], v18, s[24:27], s4 offen offset:1024 sc1
    v_mfma_f32_16x16x32_bf16 v[56:59], a[240:243], v[124:127], 0
    s_waitcnt lgkmcnt(3)
    ds_read_b128 a[100:103], v25 offset:13312
    v_mfma_f32_16x16x32_bf16 v[56:59], v[176:179], v[128:131], v[56:59]
    ds_read_b128 a[104:107], v25 offset:14336
    v_mfma_f32_16x16x32_bf16 v[56:59], v[196:199], v[132:135], v[56:59]
    v_fmac_f32 v52, v102, v88
    v_fmac_f32 v54, v102, v90
    v_fmac_f32 v46, v102, v82
    v_fmac_f32 v47, v102, v83
    v_fmac_f32 v44, v102, v80
    v_fmac_f32 v45, v102, v81
    v_fmac_f32 v53, v102, v89
    v_fmac_f32 v55, v102, v91
    v_mfma_f32_16x16x32_bf16 v[56:59], v[216:219], v[136:139], v[56:59]
    v_fmac_f32 v50, v102, v86
    v_fmac_f32 v51, v102, v87
    v_fmac_f32 v48, v102, v84
    v_fmac_f32 v49, v102, v85
    v_permlane32_swap_b32 v52, v54
    v_permlane32_swap_b32 v53, v55
    v_mul_f32 v46, v103, v46
    v_mul_f32 v47, v103, v47
    v_mfma_f32_16x16x32_bf16 v[60:63], v[220:223], v[136:139], 0
    v_mul_f32 v44, v103, v44
    v_mul_f32 v45, v103, v45
    v_mul_f32 v52, v103, v52
    v_mul_f32 v53, v103, v53
    v_exp_f32 v46, v46
    v_exp_f32 v47, v47
    v_exp_f32 v44, v44
    v_exp_f32 v45, v45
    v_mfma_f32_16x16x32_bf16 v[60:63], v[200:203], v[132:135], v[60:63]
    v_exp_f32 v52, v52
    v_exp_f32 v53, v53
    v_add_f32 v46, 1.0, v46
    v_add_f32 v47, 1.0, v47
    v_add_f32 v44, 1.0, v44
    v_add_f32 v45, 1.0, v45
    v_add_f32 v52, 1.0, v52
    v_add_f32 v53, 1.0, v53
    v_mfma_f32_16x16x32_bf16 v[60:63], v[180:183], v[128:131], v[60:63]
    v_rcp_f32 v46, v46
    v_rcp_f32 v47, v47
    v_rcp_f32 v44, v44
    v_rcp_f32 v45, v45
    v_rcp_f32 v52, v52
    v_rcp_f32 v53, v53
    v_mul_f32 v46, v46, v50
    v_mul_f32 v47, v47, v51
    v_mfma_f32_16x16x32_bf16 v[60:63], a[244:247], v[124:127], v[60:63]
    v_mul_f32 v44, v44, v48
    v_mul_f32 v45, v45, v49
    v_mul_f32 v52, v52, v54
    v_mul_f32 v53, v53, v55
    v_cvt_pk_bf16_f32 v95, v46, v47
    s_nop 1
    v_permlane16_swap_b32 v93, v95
    v_cvt_pk_bf16_f32 v94, v44, v45
    s_add_u32 s5, s35, 294912
    v_mfma_f32_16x16x32_bf16 v[64:67], a[248:251], v[124:127], 0
    v_cvt_pk_bf16_f32 v97, v52, v53
    s_nop 1
    v_permlane16_swap_b32 v96, v97
    v_permlane16_swap_b32 v92, v94
    v_mfma_f32_16x16x32_bf16 v[64:67], v[184:187], v[128:131], v[64:67]
    buffer_store_dwordx4 v[92:95], v15, s[24:27], s5 offen sc1
    v_mfma_f32_16x16x32_bf16 v[64:67], v[204:207], v[132:135], v[64:67]
    buffer_store_dwordx2 v[96:97], v17, s[24:27], s5 offen offset:512 sc1
    v_mfma_f32_16x16x32_bf16 v[64:67], v[224:227], v[136:139], v[64:67]
    ds_read_b128 a[108:111], v25 offset:15360
    v_mfma_f32_16x16x32_bf16 v[68:71], v[228:231], v[136:139], 0
    ds_read_b128 a[112:115], v25 offset:16384
    v_mfma_f32_16x16x32_bf16 v[68:71], v[208:211], v[132:135], v[68:71]
    buffer_load_dwordx4 a[152:155], v18, s[24:27], s4 offen offset:2048 sc1
    v_mfma_f32_16x16x32_bf16 v[68:71], v[188:191], v[128:131], v[68:71]
    ds_read_b128 a[116:119], v25 offset:17408
    v_mfma_f32_16x16x32_bf16 v[68:71], a[252:255], v[124:127], v[68:71]
    ds_read_b128 a[120:123], v25 offset:18432
    v_mfma_f32_16x16x32_bf16 v[72:75], v[172:175], v[124:127], 0
    buffer_load_dwordx4 a[156:159], v18, s[24:27], s4 offen offset:3072 sc1
    s_add_u32 s4, s46, 102400
    v_mfma_f32_16x16x32_bf16 v[72:75], v[192:195], v[128:131], v[72:75]
    s_waitcnt lgkmcnt(3)
    ds_read_b128 a[124:127], v25 offset:19456
    v_mfma_f32_16x16x32_bf16 v[72:75], v[212:215], v[132:135], v[72:75]
    ds_read_b128 a[128:131], v25 offset:20480
    v_mfma_f32_16x16x32_bf16 v[72:75], v[232:235], v[136:139], v[72:75]
    buffer_load_dwordx4 a[160:163], v18, s[24:27], s4 offen offset:0 sc1
    v_mfma_f32_16x16x32_bf16 v[72:75], a[48:51], v[140:143], v[72:75]
    ds_read_b128 a[132:135], v25 offset:21504
    v_mov_b32 v11, 0
    v_mfma_f32_16x16x32_bf16 v[72:75], a[68:71], v[144:147], v[72:75]
    s_mov_b64 exec, 1
    buffer_atomic_add v11, off, s[24:27], s44 offset:256 sc0 sc1
    s_mov_b64 exec, -1
    v_mfma_f32_16x16x32_bf16 v[72:75], a[88:91], v[148:151], v[72:75]
    ds_read_b128 a[136:139], v25 offset:22528
    v_mfma_f32_16x16x32_bf16 v[72:75], a[108:111], v[152:155], v[72:75]
    ds_read_b128 a[140:143], v25 offset:23552
    v_mfma_f32_16x16x32_bf16 v[68:71], a[104:107], v[152:155], v[68:71]
    buffer_load_dwordx4 a[164:167], v18, s[24:27], s4 offen offset:1024 sc1
    v_mfma_f32_16x16x32_bf16 v[68:71], a[84:87], v[148:151], v[68:71]
    v_mfma_f32_16x16x32_bf16 v[68:71], a[64:67], v[144:147], v[68:71]
    v_mfma_f32_16x16x32_bf16 v[68:71], v[248:251], v[140:143], v[68:71]
    buffer_load_dwordx4 a[168:171], v18, s[24:27], s4 offen offset:2048 sc1
    v_mfma_f32_16x16x32_bf16 v[64:67], v[244:247], v[140:143], v[64:67]
    v_mfma_f32_16x16x32_bf16 v[64:67], a[60:63], v[144:147], v[64:67]
    v_mfma_f32_16x16x32_bf16 v[64:67], a[80:83], v[148:151], v[64:67]
    buffer_load_dwordx4 a[172:175], v18, s[24:27], s4 offen offset:3072 sc1
    s_add_u32 s4, s46, 106496
    v_mfma_f32_16x16x32_bf16 v[64:67], a[100:103], v[152:155], v[64:67]
    v_mfma_f32_16x16x32_bf16 v[60:63], a[96:99], v[152:155], v[60:63]
    v_mfma_f32_16x16x32_bf16 v[60:63], a[76:79], v[148:151], v[60:63]
    v_mfma_f32_16x16x32_bf16 v[60:63], a[56:59], v[144:147], v[60:63]
    v_mfma_f32_16x16x32_bf16 v[60:63], v[240:243], v[140:143], v[60:63]
    buffer_load_dwordx4 a[176:179], v18, s[24:27], s4 offen offset:0 sc1
    v_mfma_f32_16x16x32_bf16 v[56:59], v[236:239], v[140:143], v[56:59]
    s_mov_b64 exec, s[56:57]
    ds_read_b64 v[110:111], v98 offset:25600
    s_mov_b64 exec, -1
    v_mfma_f32_16x16x32_bf16 v[56:59], a[52:55], v[144:147], v[56:59]
    s_waitcnt lgkmcnt(0)
    v_mfma_f32_16x16x32_bf16 v[56:59], a[72:75], v[148:151], v[56:59]
    v_mfma_f32_16x16x32_bf16 v[56:59], a[92:95], v[152:155], v[56:59]
    s_mov_b64 exec, s[56:57]
    ds_read_b64 v[118:119], v98 offset:20480
    s_mov_b64 exec, -1
    v_mfma_f32_16x16x32_bf16 v[56:59], a[112:115], v[156:159], v[56:59]
    s_waitcnt vmcnt(12)
    buffer_load_dwordx4 a[180:183], v18, s[24:27], s4 offen offset:1024 sc1
    v_mfma_f32_16x16x32_bf16 v[56:59], a[132:135], v[160:163], v[56:59]
    v_mfma_f32_16x16x32_bf16 v[56:59], a[8:11], v[164:167], v[56:59]
    s_mov_b64 exec, s[56:57]
    ds_read_u16 v123, v99 offset:20480
    s_mov_b64 exec, -1
    v_mfma_f32_16x16x32_bf16 v[56:59], a[28:31], v[168:171], v[56:59]
    buffer_load_dwordx4 a[184:187], v18, s[24:27], s4 offen offset:2048 sc1
    v_mfma_f32_16x16x32_bf16 v[60:63], a[32:35], v[168:171], v[60:63]
    v_mfma_f32_16x16x32_bf16 v[60:63], a[12:15], v[164:167], v[60:63]
    v_mfma_f32_16x16x32_bf16 v[60:63], a[136:139], v[160:163], v[60:63]
    v_mfma_f32_16x16x32_bf16 v[60:63], a[116:119], v[156:159], v[60:63]
    buffer_load_dwordx4 a[188:191], v18, s[24:27], s4 offen offset:3072 sc1
    v_mfma_f32_16x16x32_bf16 v[64:67], a[120:123], v[156:159], v[64:67]
    v_mfma_f32_16x16x32_bf16 v[64:67], a[140:143], v[160:163], v[64:67]
    v_mfma_f32_16x16x32_bf16 v[64:67], a[16:19], v[164:167], v[64:67]
    v_mfma_f32_16x16x32_bf16 v[64:67], a[36:39], v[168:171], v[64:67]
    v_mfma_f32_16x16x32_bf16 v[68:71], a[40:43], v[168:171], v[68:71]
    v_mfma_f32_16x16x32_bf16 v[68:71], a[20:23], v[164:167], v[68:71]
    v_mfma_f32_16x16x32_bf16 v[68:71], a[0:3], v[160:163], v[68:71]
    s_waitcnt lgkmcnt(0)
    v_mfma_f32_16x16x32_bf16 v[68:71], a[124:127], v[156:159], v[68:71]
    s_waitcnt vmcnt(11)
    s_barrier
    v_mfma_f32_16x16x32_bf16 v[72:75], a[128:131], v[156:159], v[72:75]
    s_mov_b64 exec, 1
    buffer_atomic_add v13, off, s[24:27], s43 offset:384 sc1
    s_mov_b64 exec, -1
    v_mfma_f32_16x16x32_bf16 v[72:75], a[4:7], v[160:163], v[72:75]
L_pad2:
    s_cbranch_execz L_padend
    v_mfma_f32_16x16x32_bf16 v[72:75], a[24:27], v[164:167], v[72:75]
    v_mfma_f32_16x16x32_bf16 v[72:75], a[44:47], v[168:171], v[72:75]
    s_waitcnt vmcnt(10)
    v_mfma_f32_16x16x32_bf16 v[32:35], a[240:243], a[144:147], 0
    ds_read_b32 v2, v20 offset:0
    v_perm_b32 v21, v113, v120, v22
    v_mfma_f32_16x16x32_bf16 v[32:35], v[176:179], a[148:151], v[32:35]
    v_perm_b32 v26, v105, v104, s47
    v_perm_b32 v27, v113, v112, s48
    v_mfma_f32_16x16x32_bf16 v[32:35], v[196:199], a[152:155], v[32:35]
    s_waitcnt vmcnt(8)
    v_readfirstlane_b32 s6, v11
    v_perm_b32 v28, v105, v104, s61
    v_mfma_f32_16x16x32_bf16 v[32:35], v[216:219], a[156:159], v[32:35]
    s_cmp_lt_u32 s6, 4
    s_cbranch_scc1 L_q2
L_q2_ok:
    ds_write_b128 v1, v[56:59] offset:0
    v_mfma_f32_16x16x32_bf16 v[36:39], v[220:223], a[156:159], 0
    s_add_u32 s4, s46, 196608
    v_perm_b32 v7, v113, v112, s63
    v_perm_b32 v8, v105, v104, s64
    v_mfma_f32_16x16x32_bf16 v[36:39], v[200:203], a[152:155], v[36:39]
    v_perm_b32 v9, v113, v112, s65
    v_perm_b32 v10, v105, v104, s66
    v_mfma_f32_16x16x32_bf16 v[36:39], v[180:183], a[148:151], v[36:39]
    s_waitcnt lgkmcnt(1)
    ds_write_b128 v1, v[60:63] offset:32
    v_mfma_f32_16x16x32_bf16 v[36:39], a[244:247], a[144:147], v[36:39]
    buffer_load_dwordx4 a[192:195], v18, s[24:27], s4 offen offset:0 sc1
    v_mul_f32 v2, 0xbf317218, v2
    v_mfma_f32_16x16x32_bf16 v[40:43], a[248:251], a[144:147], 0
    v_mfma_f32_16x16x32_bf16 v[40:43], v[184:187], a[148:151], v[40:43]
    ds_write_b128 v1, v[64:67] offset:64
    v_mfma_f32_16x16x32_bf16 v[40:43], v[204:207], a[152:155], v[40:43]
    buffer_load_dwordx4 a[196:199], v18, s[24:27], s4 offen offset:1024 sc1
    v_mfma_f32_16x16x32_bf16 v[40:43], v[224:227], a[156:159], v[40:43]
    v_mfma_f32_16x16x32_bf16 v[44:47], v[228:231], a[156:159], 0
    ds_write_b128 v1, v[68:71] offset:96
    v_mfma_f32_16x16x32_bf16 v[44:47], v[208:211], a[152:155], v[44:47]
    buffer_load_dwordx4 a[200:203], v18, s[24:27], s4 offen offset:2048 sc1
    v_mfma_f32_16x16x32_bf16 v[44:47], v[188:191], a[148:151], v[44:47]
    v_mfma_f32_16x16x32_bf16 v[44:47], a[252:255], a[144:147], v[44:47]
    ds_write_b128 v1, v[72:75] offset:128
    v_mfma_f32_16x16x32_bf16 v[48:51], v[172:175], a[144:147], 0
    buffer_load_dwordx4 a[204:207], v18, s[24:27], s4 offen offset:3072 sc1
    s_add_u32 s4, s46, 200704
    v_mfma_f32_16x16x32_bf16 v[48:51], v[192:195], a[148:151], v[48:51]
    v_mfma_f32_16x16x32_bf16 v[48:51], v[212:215], a[152:155], v[48:51]
    v_mfma_f32_16x16x32_bf16 v[48:51], v[232:235], a[156:159], v[48:51]
    s_waitcnt vmcnt(9)
    v_mfma_f32_16x16x32_bf16 v[48:51], a[48:51], a[160:163], v[48:51]
    v_mfma_f32_16x16x32_bf16 v[48:51], a[68:71], a[164:167], v[48:51]
    buffer_load_dwordx4 a[208:211], v18, s[24:27], s4 offen offset:0 sc1
    v_mfma_f32_16x16x32_bf16 v[48:51], a[88:91], a[168:171], v[48:51]
    v_mfma_f32_16x16x32_bf16 v[48:51], a[108:111], a[172:175], v[48:51]
    v_mfma_f32_16x16x32_bf16 v[44:47], a[104:107], a[172:175], v[44:47]
    s_waitcnt lgkmcnt(0)
    s_barrier
    buffer_load_dwordx4 a[212:215], v18, s[24:27], s4 offen offset:1024 sc1
    v_mfma_f32_16x16x32_bf16 v[44:47], a[84:87], a[168:171], v[44:47]
    ds_read_b128 v[76:79], v16 offset:0
    v_mfma_f32_16x16x32_bf16 v[44:47], a[64:67], a[164:167], v[44:47]
    ds_read_b128 v[80:83], v16 offset:160
    v_mfma_f32_16x16x32_bf16 v[44:47], v[248:251], a[160:163], v[44:47]
    ds_read_b128 v[84:87], v16 offset:5376
    v_mfma_f32_16x16x32_bf16 v[40:43], v[244:247], a[160:163], v[40:43]
    ds_read_b128 v[88:91], v16 offset:5536
    v_mfma_f32_16x16x32_bf16 v[40:43], a[60:63], a[164:167], v[40:43]
    ds_read_b128 v[92:95], v16 offset:10752
    v_mfma_f32_16x16x32_bf16 v[40:43], a[80:83], a[168:171], v[40:43]
    ds_read_b128 v[96:99], v16 offset:10912
    v_mfma_f32_16x16x32_bf16 v[40:43], a[100:103], a[172:175], v[40:43]
    ds_read_b128 v[100:103], v16 offset:16128
    v_mfma_f32_16x16x32_bf16 v[36:39], a[96:99], a[172:175], v[36:39]
    buffer_load_dwordx4 a[216:219], v18, s[24:27], s4 offen offset:2048 sc1
    v_mfma_f32_16x16x32_bf16 v[36:39], a[76:79], a[168:171], v[36:39]
    ds_read_b128 v[52:55], v16 offset:16288
    v_mfma_f32_16x16x32_bf16 v[36:39], a[56:59], a[164:167], v[36:39]
    v_mfma_f32_16x16x32_bf16 v[36:39], v[240:243], a[160:163], v[36:39]
    s_waitcnt lgkmcnt(4)
    buffer_load_dwordx4 a[220:223], v18, s[24:27], s4 offen offset:3072 sc1
    v_add_f32 v76, v76, v84
    v_mfma_f32_16x16x32_bf16 v[32:35], v[236:239], a[160:163], v[32:35]
    s_add_u32 s4, s46, 204800
    v_add_f32 v77, v77, v85
    v_add_f32 v78, v78, v86
    v_mfma_f32_16x16x32_bf16 v[32:35], a[52:55], a[164:167], v[32:35]
    v_add_f32 v79, v79, v87
    v_add_f32 v80, v80, v88
    v_mfma_f32_16x16x32_bf16 v[32:35], a[72:75], a[168:171], v[32:35]
    buffer_load_dwordx4 a[224:227], v18, s[24:27], s4 offen offset:0 sc1
    v_mov_b32 v11, 0
    v_mfma_f32_16x16x32_bf16 v[32:35], a[92:95], a[172:175], v[32:35]
    s_waitcnt vmcnt(10)
    v_add_f32 v81, v81, v89
    v_add_f32 v82, v82, v90
    v_mfma_f32_16x16x32_bf16 v[32:35], a[112:115], a[176:179], v[32:35]
    s_mov_b64 exec, 1
    buffer_atomic_add v11, off, s[24:27], s44 offset:384 sc0 sc1
    s_mov_b64 exec, -1
    v_mfma_f32_16x16x32_bf16 v[32:35], a[132:135], a[180:183], v[32:35]
    v_add_f32 v83, v83, v91
    s_waitcnt lgkmcnt(0)
    v_mfma_f32_16x16x32_bf16 v[32:35], a[8:11], a[184:187], v[32:35]
    v_add_f32 v92, v92, v100
    v_add_f32 v93, v93, v101
    v_mfma_f32_16x16x32_bf16 v[32:35], a[28:31], a[188:191], v[32:35]
    buffer_load_dwordx4 a[228:231], v18, s[24:27], s4 offen offset:1024 sc1
    v_add_f32 v94, v94, v102
    v_mfma_f32_16x16x32_bf16 v[36:39], a[32:35], a[188:191], v[36:39]
    v_add_f32 v95, v95, v103
    v_add_f32 v96, v96, v52
    v_mfma_f32_16x16x32_bf16 v[36:39], a[12:15], a[184:187], v[36:39]
    v_add_f32 v97, v97, v53
    v_add_f32 v98, v98, v54
    v_mfma_f32_16x16x32_bf16 v[36:39], a[136:139], a[180:183], v[36:39]
    buffer_load_dwordx4 a[232:235], v18, s[24:27], s4 offen offset:2048 sc1
    v_add_f32 v99, v99, v55
    v_mfma_f32_16x16x32_bf16 v[36:39], a[116:119], a[176:179], v[36:39]
    v_add_f32 v76, v76, v92
    v_add_f32 v77, v77, v93
    v_mfma_f32_16x16x32_bf16 v[40:43], a[120:123], a[176:179], v[40:43]
    v_add_f32 v78, v78, v94
    v_add_f32 v79, v79, v95
    v_mfma_f32_16x16x32_bf16 v[40:43], a[140:143], a[180:183], v[40:43]
    buffer_load_dwordx4 a[236:239], v18, s[24:27], s4 offen offset:3072 sc1
    v_add_f32 v80, v80, v96
    v_mfma_f32_16x16x32_bf16 v[40:43], a[16:19], a[184:187], v[40:43]
    v_add_f32 v81, v81, v97
    v_add_f32 v82, v82, v98
    v_mfma_f32_16x16x32_bf16 v[40:43], a[36:39], a[188:191], v[40:43]
    v_add_f32 v83, v83, v99
    v_fmac_f32 v21, v2, v76
    v_mfma_f32_16x16x32_bf16 v[44:47], a[40:43], a[188:191], v[44:47]
    v_fmac_f32 v26, v2, v77
    v_fmac_f32 v27, v2, v78
    v_mfma_f32_16x16x32_bf16 v[44:47], a[20:23], a[184:187], v[44:47]
    v_fmac_f32 v28, v2, v79
    v_fmac_f32 v7, v2, v80
    v_mfma_f32_16x16x32_bf16 v[44:47], a[0:3], a[180:183], v[44:47]
    v_fmac_f32 v8, v2, v81
    v_fmac_f32 v9, v2, v82
    v_mfma_f32_16x16x32_bf16 v[44:47], a[124:127], a[176:179], v[44:47]
    v_fmac_f32 v10, v2, v83
    v_cvt_pk_bf16_f32 v84, v21, v26
    v_mfma_f32_16x16x32_bf16 v[48:51], a[128:131], a[176:179], v[48:51]
    v_cvt_pk_bf16_f32 v85, v27, v28
    v_cvt_pk_bf16_f32 v86, v7, v8
    v_mfma_f32_16x16x32_bf16 v[48:51], a[4:7], a[180:183], v[48:51]
    v_cvt_pk_bf16_f32 v87, v9, v10
    v_mfma_f32_16x16x32_bf16 v[48:51], a[24:27], a[184:187], v[48:51]
    buffer_store_dwordx4 v[84:87], v19, s[20:23], s67 offen sc1
    v_mfma_f32_16x16x32_bf16 v[48:51], a[44:47], a[188:191], v[48:51]
    s_waitcnt vmcnt(10)
    v_mfma_f32_16x16x32_bf16 v[56:59], a[240:243], a[192:195], 0
    ds_read_b32 v2, v20 offset:256
    v_perm_b32 v21, v115, v121, v22
    v_mfma_f32_16x16x32_bf16 v[56:59], v[176:179], a[196:199], v[56:59]
    v_perm_b32 v26, v107, v106, s47
    v_perm_b32 v27, v115, v114, s48
    v_mfma_f32_16x16x32_bf16 v[56:59], v[196:199], a[200:203], v[56:59]
    v_perm_b32 v28, v107, v106, s61
    v_perm_b32 v7, v115, v114, s63
    v_mfma_f32_16x16x32_bf16 v[56:59], v[216:219], a[204:207], v[56:59]
    ds_write_b128 v1, v[32:35] offset:21504
    v_mfma_f32_16x16x32_bf16 v[60:63], v[220:223], a[204:207], 0
    v_perm_b32 v8, v107, v106, s64
    v_perm_b32 v9, v115, v114, s65
    v_mfma_f32_16x16x32_bf16 v[60:63], v[200:203], a[200:203], v[60:63]
    v_perm_b32 v10, v107, v106, s66
    s_waitcnt lgkmcnt(1)
    v_mfma_f32_16x16x32_bf16 v[60:63], v[180:183], a[196:199], v[60:63]
    ds_write_b128 v1, v[36:39] offset:21536
    v_mfma_f32_16x16x32_bf16 v[60:63], a[244:247], a[192:195], v[60:63]
    v_mul_f32 v2, 0xbf317218, v2
    v_mfma_f32_16x16x32_bf16 v[64:67], a[248:251], a[192:195], 0
    v_mfma_f32_16x16x32_bf16 v[64:67], v[184:187], a[196:199], v[64:67]
    ds_write_b128 v1, v[40:43] offset:21568
    v_mfma_f32_16x16x32_bf16 v[64:67], v[204:207], a[200:203], v[64:67]
    v_mfma_f32_16x16x32_bf16 v[64:67], v[224:227], a[204:207], v[64:67]
    v_mfma_f32_16x16x32_bf16 v[68:71], v[228:231], a[204:207], 0
    ds_write_b128 v1, v[44:47] offset:21600
    v_mfma_f32_16x16x32_bf16 v[68:71], v[208:211], a[200:203], v[68:71]
    v_mfma_f32_16x16x32_bf16 v[68:71], v[188:191], a[196:199], v[68:71]
    v_mfma_f32_16x16x32_bf16 v[68:71], a[252:255], a[192:195], v[68:71]
    ds_write_b128 v1, v[48:51] offset:21632
    v_mfma_f32_16x16x32_bf16 v[72:75], v[172:175], a[192:195], 0
    s_waitcnt vmcnt(4)
    v_readfirstlane_b32 s6, v11
    v_mfma_f32_16x16x32_bf16 v[72:75], v[192:195], a[196:199], v[72:75]
    s_cmp_lt_u32 s6, 4
    s_cbranch_scc1 L_q3
L_q3_ok:
    v_mfma_f32_16x16x32_bf16 v[72:75], v[212:215], a[200:203], v[72:75]
    s_add_u32 s4, s46, 294912
    v_mfma_f32_16x16x32_bf16 v[72:75], v[232:235], a[204:207], v[72:75]
    v_mfma_f32_16x16x32_bf16 v[72:75], a[48:51], a[208:211], v[72:75]
    buffer_load_dwordx4 v[124:127], v18, s[24:27], s4 offen offset:0 sc1
    v_mfma_f32_16x16x32_bf16 v[72:75], a[68:71], a[212:215], v[72:75]
    v_mfma_f32_16x16x32_bf16 v[72:75], a[88:91], a[216:219], v[72:75]
    v_mfma_f32_16x16x32_bf16 v[72:75], a[108:111], a[220:223], v[72:75]
    buffer_load_dwordx4 v[128:131], v18, s[24:27], s4 offen offset:1024 sc1
    v_mfma_f32_16x16x32_bf16 v[68:71], a[104:107], a[220:223], v[68:71]
    s_waitcnt lgkmcnt(0)
    s_barrier
    v_mfma_f32_16x16x32_bf16 v[68:71], a[84:87], a[216:219], v[68:71]
    ds_read_b128 v[76:79], v16 offset:21504
    v_mfma_f32_16x16x32_bf16 v[68:71], a[64:67], a[212:215], v[68:71]
    ds_read_b128 v[80:83], v16 offset:21664
    v_mfma_f32_16x16x32_bf16 v[68:71], v[248:251], a[208:211], v[68:71]
    ds_read_b128 v[84:87], v16 offset:26880
    v_mfma_f32_16x16x32_bf16 v[64:67], v[244:247], a[208:211], v[64:67]
    ds_read_b128 v[88:91], v16 offset:27040
    v_mfma_f32_16x16x32_bf16 v[64:67], a[60:63], a[212:215], v[64:67]
    ds_read_b128 v[92:95], v16 offset:32256
    v_mfma_f32_16x16x32_bf16 v[64:67], a[80:83], a[216:219], v[64:67]
    ds_read_b128 v[96:99], v16 offset:32416
    v_mfma_f32_16x16x32_bf16 v[64:67], a[100:103], a[220:223], v[64:67]
    ds_read_b128 v[100:103], v16 offset:37632
    v_mfma_f32_16x16x32_bf16 v[60:63], a[96:99], a[220:223], v[60:63]
    buffer_load_dwordx4 v[132:135], v18, s[24:27], s4 offen offset:2048 sc1
    v_mfma_f32_16x16x32_bf16 v[60:63], a[76:79], a[216:219], v[60:63]
    ds_read_b128 v[52:55], v16 offset:37792
    v_mfma_f32_16x16x32_bf16 v[60:63], a[56:59], a[212:215], v[60:63]
    v_mfma_f32_16x16x32_bf16 v[60:63], v[240:243], a[208:211], v[60:63]
    s_waitcnt lgkmcnt(4)
    buffer_load_dwordx4 v[136:139], v18, s[24:27], s4 offen offset:3072 sc1
    v_add_f32 v76, v76, v84
    v_mfma_f32_16x16x32_bf16 v[56:59], v[236:239], a[208:211], v[56:59]
    s_add_u32 s4, s46, 299008
    v_add_f32 v77, v77, v85
    v_add_f32 v78, v78, v86
    v_mfma_f32_16x16x32_bf16 v[56:59], a[52:55], a[212:215], v[56:59]
    v_add_f32 v79, v79, v87
    v_add_f32 v80, v80, v88
    v_mfma_f32_16x16x32_bf16 v[56:59], a[72:75], a[216:219], v[56:59]
    buffer_load_dwordx4 v[140:143], v18, s[24:27], s4 offen offset:0 sc1
    v_add_f32 v81, v81, v89
    v_mfma_f32_16x16x32_bf16 v[56:59], a[92:95], a[220:223], v[56:59]
    s_waitcnt vmcnt(6)
    v_add_f32 v82, v82, v90
    v_add_f32 v83, v83, v91
    v_mfma_f32_16x16x32_bf16 v[56:59], a[112:115], a[224:227], v[56:59]
    s_waitcnt lgkmcnt(0)
    v_add_f32 v92, v92, v100
    v_add_f32 v93, v93, v101
    v_mfma_f32_16x16x32_bf16 v[56:59], a[132:135], a[228:231], v[56:59]
    buffer_load_dwordx4 v[144:147], v18, s[24:27], s4 offen offset:1024 sc1
    v_add_f32 v94, v94, v102
    v_mfma_f32_16x16x32_bf16 v[56:59], a[8:11], a[232:235], v[56:59]
    v_add_f32 v95, v95, v103
    v_add_f32 v96, v96, v52
    v_mfma_f32_16x16x32_bf16 v[56:59], a[28:31], a[236:239], v[56:59]
    v_add_f32 v97, v97, v53
    v_add_f32 v98, v98, v54
    v_mfma_f32_16x16x32_bf16 v[60:63], a[32:35], a[236:239], v[60:63]
    buffer_load_dwordx4 v[148:151], v18, s[24:27], s4 offen offset:2048 sc1
    v_add_f32 v99, v99, v55
    v_mfma_f32_16x16x32_bf16 v[60:63], a[12:15], a[232:235], v[60:63]
    v_add_f32 v76, v76, v92
    v_add_f32 v77, v77, v93
    v_mfma_f32_16x16x32_bf16 v[60:63], a[136:139], a[228:231], v[60:63]
    v_add_f32 v78, v78, v94
    v_add_f32 v79, v79, v95
    v_mfma_f32_16x16x32_bf16 v[60:63], a[116:119], a[224:227], v[60:63]
    buffer_load_dwordx4 v[152:155], v18, s[24:27], s4 offen offset:3072 sc1
    s_add_u32 s4, s46, 303104
    v_mfma_f32_16x16x32_bf16 v[64:67], a[120:123], a[224:227], v[64:67]
    v_add_f32 v80, v80, v96
    v_add_f32 v81, v81, v97
    v_mfma_f32_16x16x32_bf16 v[64:67], a[140:143], a[228:231], v[64:67]
    ds_write_b128 v1, v[56:59] offset:0
    v_mfma_f32_16x16x32_bf16 v[64:67], a[16:19], a[232:235], v[64:67]
    buffer_load_dwordx4 v[156:159], v18, s[24:27], s4 offen offset:0 sc1
    v_add_f32 v82, v82, v98
    v_mfma_f32_16x16x32_bf16 v[64:67], a[36:39], a[236:239], v[64:67]
    v_add_f32 v83, v83, v99
    v_fmac_f32 v21, v2, v76
    v_mfma_f32_16x16x32_bf16 v[68:71], a[40:43], a[236:239], v[68:71]
    v_fmac_f32 v26, v2, v77
    v_fmac_f32 v27, v2, v78
    v_mfma_f32_16x16x32_bf16 v[68:71], a[20:23], a[232:235], v[68:71]
    ds_write_b128 v1, v[60:63] offset:32
    v_mfma_f32_16x16x32_bf16 v[68:71], a[0:3], a[228:231], v[68:71]
    buffer_load_dwordx4 v[160:163], v18, s[24:27], s4 offen offset:1024 sc1
    v_fmac_f32 v28, v2, v79
    buffer_load_dwordx4 v[164:167], v18, s[24:27], s4 offen offset:2048 sc1
    buffer_load_dwordx4 v[168:171], v18, s[24:27], s4 offen offset:3072 sc1
    v_mfma_f32_16x16x32_bf16 v[68:71], a[124:127], a[224:227], v[68:71]
    v_fmac_f32 v7, v2, v80
    v_fmac_f32 v8, v2, v81
    v_mfma_f32_16x16x32_bf16 v[72:75], a[128:131], a[224:227], v[72:75]
    v_fmac_f32 v9, v2, v82
    v_fmac_f32 v10, v2, v83
    v_mfma_f32_16x16x32_bf16 v[72:75], a[4:7], a[228:231], v[72:75]
    ds_write_b128 v1, v[64:67] offset:64
    v_mfma_f32_16x16x32_bf16 v[72:75], a[24:27], a[232:235], v[72:75]
    v_cvt_pk_bf16_f32 v84, v21, v26
    v_cvt_pk_bf16_f32 v85, v27, v28
    v_mfma_f32_16x16x32_bf16 v[72:75], a[44:47], a[236:239], v[72:75]
    s_waitcnt vmcnt(11)
    v_cvt_pk_bf16_f32 v86, v7, v8
    v_cvt_pk_bf16_f32 v87, v9, v10
    buffer_store_dwordx4 v[84:87], v254, s[20:23], s67 offen sc1
    v_mfma_f32_16x16x32_bf16 v[32:35], a[240:243], v[124:127], 0
    s_waitcnt vmcnt(11)
    ds_read_b32 v2, v20 offset:512
    v_perm_b32 v21, v117, v122, v22
    v_mfma_f32_16x16x32_bf16 v[32:35], v[176:179], v[128:131], v[32:35]
    s_waitcnt vmcnt(10)
    ds_write_b128 v1, v[68:71] offset:96
    v_mfma_f32_16x16x32_bf16 v[32:35], v[196:199], v[132:135], v[32:35]
    s_waitcnt vmcnt(9)
    v_perm_b32 v26, v109, v108, s47
    v_perm_b32 v27, v117, v116, s48
    v_mfma_f32_16x16x32_bf16 v[32:35], v[216:219], v[136:139], v[32:35]
    v_perm_b32 v28, v109, v108, s61
    v_perm_b32 v7, v117, v116, s63
    v_mfma_f32_16x16x32_bf16 v[36:39], v[220:223], v[136:139], 0
    v_perm_b32 v8, v109, v108, s64
    v_perm_b32 v9, v117, v116, s65
    v_mfma_f32_16x16x32_bf16 v[36:39], v[200:203], v[132:135], v[36:39]
    ds_write_b128 v1, v[72:75] offset:128
    v_mfma_f32_16x16x32_bf16 v[36:39], v[180:183], v[128:131], v[36:39]
    v_perm_b32 v10, v109, v108, s66
    s_waitcnt lgkmcnt(2)
    v_mfma_f32_16x16x32_bf16 v[36:39], a[244:247], v[124:127], v[36:39]
    v_mul_f32 v2, 0xbf317218, v2
    v_mfma_f32_16x16x32_bf16 v[40:43], a[248:251], v[124:127], 0
    v_mfma_f32_16x16x32_bf16 v[40:43], v[184:187], v[128:131], v[40:43]
    v_mfma_f32_16x16x32_bf16 v[40:43], v[204:207], v[132:135], v[40:43]
    v_mfma_f32_16x16x32_bf16 v[40:43], v[224:227], v[136:139], v[40:43]
    s_waitcnt lgkmcnt(0)
    s_barrier
    v_mfma_f32_16x16x32_bf16 v[44:47], v[228:231], v[136:139], 0
    ds_read_b128 v[76:79], v16 offset:0
    v_mfma_f32_16x16x32_bf16 v[44:47], v[208:211], v[132:135], v[44:47]
    ds_read_b128 v[80:83], v16 offset:160
    v_mfma_f32_16x16x32_bf16 v[44:47], v[188:191], v[128:131], v[44:47]
    ds_read_b128 v[84:87], v16 offset:5376
    v_mfma_f32_16x16x32_bf16 v[44:47], a[252:255], v[124:127], v[44:47]
    ds_read_b128 v[88:91], v16 offset:5536
    v_mfma_f32_16x16x32_bf16 v[48:51], v[172:175], v[124:127], 0
    ds_read_b128 v[92:95], v16 offset:10752
    v_mfma_f32_16x16x32_bf16 v[48:51], v[192:195], v[128:131], v[48:51]
    ds_read_b128 v[96:99], v16 offset:10912
    v_mfma_f32_16x16x32_bf16 v[48:51], v[212:215], v[132:135], v[48:51]
    ds_read_b128 v[100:103], v16 offset:16128
    v_mfma_f32_16x16x32_bf16 v[48:51], v[232:235], v[136:139], v[48:51]
    s_waitcnt vmcnt(8)
    ds_read_b128 v[52:55], v16 offset:16288
    v_mfma_f32_16x16x32_bf16 v[48:51], a[48:51], v[140:143], v[48:51]
    s_waitcnt vmcnt(7)
    v_mfma_f32_16x16x32_bf16 v[48:51], a[68:71], v[144:147], v[48:51]
    s_waitcnt vmcnt(6)
    v_mfma_f32_16x16x32_bf16 v[48:51], a[88:91], v[148:151], v[48:51]
    s_waitcnt vmcnt(5)
    s_waitcnt lgkmcnt(4)
    v_add_f32 v76, v76, v84
    v_mfma_f32_16x16x32_bf16 v[48:51], a[108:111], v[152:155], v[48:51]
    v_add_f32 v77, v77, v85
    v_add_f32 v78, v78, v86
    v_mfma_f32_16x16x32_bf16 v[44:47], a[104:107], v[152:155], v[44:47]
    v_add_f32 v79, v79, v87
    v_add_f32 v80, v80, v88
    v_mfma_f32_16x16x32_bf16 v[44:47], a[84:87], v[148:151], v[44:47]
    v_add_f32 v81, v81, v89
    v_add_f32 v82, v82, v90
    v_mfma_f32_16x16x32_bf16 v[44:47], a[64:67], v[144:147], v[44:47]
    v_add_f32 v83, v83, v91
    s_waitcnt lgkmcnt(0)
    v_mfma_f32_16x16x32_bf16 v[44:47], v[248:251], v[140:143], v[44:47]
    v_add_f32 v92, v92, v100
    v_add_f32 v93, v93, v101
    v_mfma_f32_16x16x32_bf16 v[40:43], v[244:247], v[140:143], v[40:43]
    v_add_f32 v94, v94, v102
    v_add_f32 v95, v95, v103
    v_mfma_f32_16x16x32_bf16 v[40:43], a[60:63], v[144:147], v[40:43]
    v_add_f32 v96, v96, v52
    v_add_f32 v97, v97, v53
    v_mfma_f32_16x16x32_bf16 v[40:43], a[80:83], v[148:151], v[40:43]
    v_add_f32 v98, v98, v54
    v_add_f32 v99, v99, v55
    v_mfma_f32_16x16x32_bf16 v[40:43], a[100:103], v[152:155], v[40:43]
    v_add_f32 v76, v76, v92
    v_add_f32 v77, v77, v93
    v_mfma_f32_16x16x32_bf16 v[36:39], a[96:99], v[152:155], v[36:39]
    v_add_f32 v78, v78, v94
    v_add_f32 v79, v79, v95
    v_mfma_f32_16x16x32_bf16 v[36:39], a[76:79], v[148:151], v[36:39]
    v_add_f32 v80, v80, v96
    v_add_f32 v81, v81, v97
    v_mfma_f32_16x16x32_bf16 v[36:39], a[56:59], v[144:147], v[36:39]
    v_add_f32 v82, v82, v98
    v_add_f32 v83, v83, v99
    v_mfma_f32_16x16x32_bf16 v[36:39], v[240:243], v[140:143], v[36:39]
    v_fmac_f32 v21, v2, v76
    v_fmac_f32 v26, v2, v77
    v_mfma_f32_16x16x32_bf16 v[32:35], v[236:239], v[140:143], v[32:35]
    v_fmac_f32 v27, v2, v78
    v_fmac_f32 v28, v2, v79
    v_mfma_f32_16x16x32_bf16 v[32:35], a[52:55], v[144:147], v[32:35]
    v_fmac_f32 v7, v2, v80
    v_fmac_f32 v8, v2, v81
    v_mfma_f32_16x16x32_bf16 v[32:35], a[72:75], v[148:151], v[32:35]
    v_fmac_f32 v9, v2, v82
    v_fmac_f32 v10, v2, v83
    v_mfma_f32_16x16x32_bf16 v[32:35], a[92:95], v[152:155], v[32:35]
    s_waitcnt vmcnt(4)
    v_cvt_pk_bf16_f32 v84, v21, v26
    v_cvt_pk_bf16_f32 v85, v27, v28
    v_mfma_f32_16x16x32_bf16 v[32:35], a[112:115], v[156:159], v[32:35]
    s_waitcnt vmcnt(3)
    v_cvt_pk_bf16_f32 v86, v7, v8
    v_cvt_pk_bf16_f32 v87, v9, v10
    v_mfma_f32_16x16x32_bf16 v[32:35], a[132:135], v[160:163], v[32:35]
    s_waitcnt vmcnt(2)
    s_add_u32 s5, s68, 1310720
    v_mfma_f32_16x16x32_bf16 v[32:35], a[8:11], v[164:167], v[32:35]
    s_waitcnt vmcnt(1)
    buffer_store_dwordx4 v[84:87], v24, s[20:23], s5 offen sc1
    v_mfma_f32_16x16x32_bf16 v[32:35], a[28:31], v[168:171], v[32:35]
    ds_read_b32 v2, v20 offset:768
    v_perm_b32 v21, v119, v123, v22
    v_mfma_f32_16x16x32_bf16 v[36:39], a[32:35], v[168:171], v[36:39]
    v_perm_b32 v26, v111, v110, s47
    v_perm_b32 v27, v119, v118, s48
    v_mfma_f32_16x16x32_bf16 v[36:39], a[12:15], v[164:167], v[36:39]
    v_perm_b32 v28, v111, v110, s61
    v_perm_b32 v7, v119, v118, s63
    v_mfma_f32_16x16x32_bf16 v[36:39], a[136:139], v[160:163], v[36:39]
    v_perm_b32 v8, v111, v110, s64
    v_perm_b32 v9, v119, v118, s65
    v_mfma_f32_16x16x32_bf16 v[36:39], a[116:119], v[156:159], v[36:39]
    v_perm_b32 v10, v111, v110, s66
    s_waitcnt lgkmcnt(0)
    v_mfma_f32_16x16x32_bf16 v[40:43], a[120:123], v[156:159], v[40:43]
    ds_write_b128 v1, v[32:35] offset:21504
    v_mfma_f32_16x16x32_bf16 v[40:43], a[140:143], v[160:163], v[40:43]
    v_mul_f32 v2, 0xbf317218, v2
    v_mfma_f32_16x16x32_bf16 v[40:43], a[16:19], v[164:167], v[40:43]
    v_mfma_f32_16x16x32_bf16 v[40:43], a[36:39], v[168:171], v[40:43]
    v_mfma_f32_16x16x32_bf16 v[44:47], a[40:43], v[168:171], v[44:47]
    ds_write_b128 v1, v[36:39] offset:21536
    v_mfma_f32_16x16x32_bf16 v[44:47], a[20:23], v[164:167], v[44:47]
    v_mfma_f32_16x16x32_bf16 v[44:47], a[0:3], v[160:163], v[44:47]
    v_mfma_f32_16x16x32_bf16 v[44:47], a[124:127], v[156:159], v[44:47]
    v_mfma_f32_16x16x32_bf16 v[48:51], a[128:131], v[156:159], v[48:51]
    s_nop 1
    ds_write_b128 v1, v[40:43] offset:21568
    v_mfma_f32_16x16x32_bf16 v[48:51], a[4:7], v[160:163], v[48:51]
    v_mfma_f32_16x16x32_bf16 v[48:51], a[24:27], v[164:167], v[48:51]
    v_mfma_f32_16x16x32_bf16 v[48:51], a[44:47], v[168:171], v[48:51]
    s_nop 0
    ds_write_b128 v1, v[44:47] offset:21600
    s_nop 5
    ds_write_b128 v1, v[48:51] offset:21632
    s_waitcnt lgkmcnt(0)
    s_barrier
    ds_read_b128 v[76:79], v16 offset:21504
    ds_read_b128 v[80:83], v16 offset:21664
    ds_read_b128 v[84:87], v16 offset:26880
    ds_read_b128 v[88:91], v16 offset:27040
    ds_read_b128 v[92:95], v16 offset:32256
    ds_read_b128 v[96:99], v16 offset:32416
    ds_read_b128 v[100:103], v16 offset:37632
    ds_read_b128 v[52:55], v16 offset:37792
    s_waitcnt lgkmcnt(5)
    v_pk_add_f32 v[76:77], v[76:77], v[84:85]
    v_pk_add_f32 v[78:79], v[78:79], v[86:87]
    s_waitcnt lgkmcnt(4)
    v_pk_add_f32 v[80:81], v[80:81], v[88:89]
    v_pk_add_f32 v[82:83], v[82:83], v[90:91]
    s_waitcnt lgkmcnt(1)
    v_pk_add_f32 v[92:93], v[92:93], v[100:101]
    v_pk_add_f32 v[94:95], v[94:95], v[102:103]
    s_waitcnt lgkmcnt(0)
    v_pk_add_f32 v[96:97], v[96:97], v[52:53]
    v_pk_add_f32 v[98:99], v[98:99], v[54:55]
    v_pk_add_f32 v[76:77], v[76:77], v[92:93]
    v_pk_add_f32 v[78:79], v[78:79], v[94:95]
    v_pk_add_f32 v[80:81], v[80:81], v[96:97]
    v_pk_add_f32 v[82:83], v[82:83], v[98:99]
    v_fmac_f32 v21, v2, v76
    v_fmac_f32 v26, v2, v77
    v_fmac_f32 v27, v2, v78
    v_fmac_f32 v28, v2, v79
    v_fmac_f32 v7, v2, v80
    v_fmac_f32 v8, v2, v81
    v_fmac_f32 v9, v2, v82
    v_fmac_f32 v10, v2, v83
    v_cvt_pk_bf16_f32 v84, v21, v26
    v_cvt_pk_bf16_f32 v85, v27, v28
    v_cvt_pk_bf16_f32 v86, v7, v8
    v_cvt_pk_bf16_f32 v87, v9, v10
    s_add_u32 s5, s68, 0
    buffer_store_dwordx4 v[84:87], v24, s[20:23], s5 offen
L_end:
    s_endpgm
L_q0:
    s_mov_b32 s50, 0
    s_waitcnt lgkmcnt(0)
    s_max_u32 s6, s72, s76
    s_cmp_ge_u32 s6, 4
    s_cbranch_scc1 L_q0_ok
L_q0_l:
    s_mov_b32 s6, 0
    s_atomic_add s6, s[54:55], 0 glc
    s_waitcnt lgkmcnt(0)
    s_cmp_ge_u32 s6, 4
    s_cbranch_scc1 L_q0_ok
    s_add_u32 s50, s50, 1
    s_cmp_le_u32 s50, 60000
    s_cbranch_scc1 L_q0_l
    s_branch L_q0_ok
L_q1:
    s_mov_b32 s50, 0
L_q1_l:
    s_mov_b32 s6, 0
    s_atomic_add s6, s[54:55], 128 glc
    s_waitcnt lgkmcnt(0)
    s_cmp_ge_u32 s6, 4
    s_cbranch_scc1 L_q1_ok
    s_add_u32 s50, s50, 1
    s_cmp_le_u32 s50, 60000
    s_cbranch_scc1 L_q1_l
    s_branch L_q1_ok
L_q2:
    s_mov_b32 s50, 0
L_q2_l:
    s_mov_b32 s6, 0
    s_atomic_add s6, s[54:55], 256 glc
    s_waitcnt lgkmcnt(0)
    s_cmp_ge_u32 s6, 4
    s_cbranch_scc1 L_q2_ok
    s_add_u32 s50, s50, 1
    s_cmp_le_u32 s50, 60000
    s_cbranch_scc1 L_q2_l
    s_branch L_q2_ok
L_q3:
    s_mov_b32 s50, 0
L_q3_l:
    s_mov_b32 s6, 0
    s_atomic_add s6, s[54:55], 384 glc
    s_waitcnt lgkmcnt(0)
    s_cmp_ge_u32 s6, 4
    s_cbranch_scc1 L_q3_ok
    s_add_u32 s50, s50, 1
    s_cmp_le_u32 s50, 60000
    s_cbranch_scc1 L_q3_l
    s_branch L_q3_ok
.section .rodata,"a"
.p2align 6
.amdhsa_kernel sequential_preLN__spectral_fnet__glu_gated_glu__prompt_kernel
  .amdhsa_next_free_vgpr 512
  .amdhsa_next_free_sgpr 102
  .amdhsa_accum_offset 256
  .amdhsa_group_segment_fixed_size 0
  .amdhsa_kernarg_size 96
  .amdhsa_user_sgpr_count 2
  .amdhsa_user_sgpr_kernarg_segment_ptr 1
  .amdhsa_system_sgpr_workgroup_id_x 1
.end_amdhsa_kernel
```
